```python
import torch

def _softmax(x, axis=-1):
    return torch.softmax(x, dim=axis)
def _gelu(x):
    return torch.nn.functional.gelu(x, approximate="tanh")
def _silu(x):
    return torch.nn.functional.silu(x)
def _sigmoid(x):
    return torch.sigmoid(x)
def _layernorm(x, axis=-1, eps=1e-5):
    m = x.mean(dim=axis, keepdim=True)
    v = x.var(dim=axis, keepdim=True, unbiased=False)
    return (x - m) / torch.sqrt(v + eps)
def _scatter_add(tgt, idx, src, axis=0):
    return tgt.clone().index_add_(axis, idx, src)
def _segment_sum(src, seg, n):
    out = torch.zeros((n,) + src.shape[1:], dtype=src.dtype)
    return out.index_add_(0, seg, src)
def _pad(x, pw):
    flat = tuple(v for pair in reversed(pw) for v in pair)
    return torch.nn.functional.pad(x, flat)

kernel_name = 'gated_mix__mha_block_cached__moe_arch_mod__decode'

def setup_inputs():

    _w = (lambda a: (lambda t: t.to(torch.bfloat16) if t.is_floating_point() else t)(torch.as_tensor(a)))
    def _A_setup():
        B, Sq, D = 4, 1, 1024
        H, Sk, Dh = 32, 8192, 128
        return {
            "x": _w((lambda *s: torch.randn(*s, dtype=torch.bfloat16) * 0.05)(B, Sq, D)),
            "k_cache": _w((lambda *s: torch.randn(*s, dtype=torch.bfloat16) * 6.4)(B, H, Sk, Dh)),
            "v_cache": _w((lambda *s: torch.randn(*s, dtype=torch.bfloat16) * 0.4)(B, H, Sk, Dh)),
            "wq": _w((lambda *s: torch.randn(*s, dtype=torch.bfloat16) * 6.4)(D, H * Dh) * (D ** -0.5)),
            "wo": _w((lambda *s: torch.randn(*s, dtype=torch.bfloat16) * 0.4)(H * Dh, D) * ((H * Dh) ** -0.5)),
        }
    _A_in = _A_setup()

    def _B_setup():
        B, S, D, F, C = 4, 1, 1024, 3584, 1
        return {
            "x": _w((lambda *s: torch.randn(*s, dtype=torch.bfloat16) * 0.05)(B, S, D)),
            "w_r": _w((lambda *s: torch.randn(*s, dtype=torch.bfloat16) * 3.2)(D)),
            "w_gate": _w((lambda *s: torch.randn(*s, dtype=torch.bfloat16) * 0.1)(D, F)),
            "w_up": _w((lambda *s: torch.randn(*s, dtype=torch.bfloat16) * 0.1)(D, F)),
            "w_down": _w((lambda *s: torch.randn(*s, dtype=torch.bfloat16) * 0.1)(F, D)),
        }
    _B_in = _B_setup()

    return {
        "A_x": _A_in["x"],
        "A_k_cache": _A_in["k_cache"],
        "A_v_cache": _A_in["v_cache"],
        "A_wq": _A_in["wq"],
        "A_wo": _A_in["wo"],
        "B_x": _B_in["x"],
        "B_w_r": _B_in["w_r"],
        "B_w_gate": _B_in["w_gate"],
        "B_w_up": _B_in["w_up"],
        "B_w_down": _B_in["w_down"],
        "gate_w": _w((lambda *s: torch.randn(*s, dtype=torch.bfloat16) * 0.05)(1024) * 16.0),
    }

def reference(A_x, A_k_cache, A_v_cache, A_wq, A_wo, B_x, B_w_r, B_w_gate, B_w_up, B_w_down, gate_w):
    def _A_ref(x, k_cache, v_cache, wq, wo):
        B, Sq, D = x.shape
        H, Dh = 32, 128
        q = (lambda x, *d: x.permute(*d))((x @ wq).reshape(B, Sq, H, Dh), 0, 2, 1, 3)
        scores = torch.einsum("bhqd,bhkd->bhqk", q, k_cache) * (Dh ** -0.5)
        p = _softmax(scores, axis=-1)
        o = torch.einsum("bhqk,bhkd->bhqd", p, v_cache)
        return (lambda x, *d: x.permute(*d))(o, 0, 2, 1, 3).reshape(B, Sq, H * Dh) @ wo

    def _B_ref(x, w_r, w_gate, w_up, w_down):
        B, S, D = x.shape
        C = 1
        r = x @ w_r
        idx = torch.argsort(-r, axis=-1)[:, :C]
        idx_e = (lambda x, n, axis: torch.repeat_interleave(x, n, dim=axis))(idx.reshape(B, C, 1), D, axis=2)
        x_sel = (lambda x, i, axis: torch.take_along_dim(x, i, dim=axis))(x, idx_e, axis=1)
        g = _silu(x_sel @ w_gate)
        u = x_sel @ w_up
        y = (g * u) @ w_down
        r_sel = _sigmoid((lambda x, i, axis: torch.take_along_dim(x, i, dim=axis))(r, idx, axis=1))
        y = y * r_sel.reshape(B, C, 1)
        b_off = (torch.arange(B) * S).reshape(B, 1)
        flat_idx = (idx + b_off).reshape(B * C)
        zero = (x * 0.0).reshape(B * S, D)
        upd = _scatter_add(zero, flat_idx, y.reshape(B * C, D), axis=0)
        return x + upd.reshape(B, S, D)

    x = A_x
    g = _sigmoid((x * gate_w).sum(-1, keepdims=True))
    a = _A_ref(x, A_k_cache, A_v_cache, A_wq, A_wo)
    b = _B_ref(x, B_w_r, B_w_gate, B_w_up, B_w_down)
    return g * a + (1 - g) * b
```

```asm
; @launch grid=(256,1,1) block=(512,1,1) lds=159744
.amdgcn_target "amdgcn-amd-amdhsa--gfx950"
.text
.globl gated_mix__mha_block_cached__moe_arch_mod__decode_kernel
.p2align 8
.type gated_mix__mha_block_cached__moe_arch_mod__decode_kernel,@function
gated_mix__mha_block_cached__moe_arch_mod__decode_kernel:
    s_cmp_ge_u32 s2, 256
    s_cbranch_scc1 L_end
    s_load_dwordx16 s[16:31], s[0:1], 0
    s_load_dwordx8 s[32:39], s[0:1], 64
    s_load_dwordx4 s[40:43], s[0:1], 96
    v_lshrrev_b32 v1, 6, v0
    v_and_b32 v0, 63, v0
    s_lshr_b32 s6, s2, 3
    s_and_b32 s5, s2, 7
    s_mul_i32 s4, s5, 4
    s_add_u32 s4, s4, s6
    s_and_b32 s4, s4, 31
    s_and_b32 s11, s5, 0
    s_xor_b32 s4, s4, s11
    s_lshl_b32 s11, s4, 3
    s_add_u32 s11, s11, s5
    v_readfirstlane_b32 s3, v1
    v_mov_b32 v253, 0
    s_nop 3
    s_cmp_lt_u32 s3, 4
    s_cbranch_scc1 L_stream
    s_setprio 3
    s_sub_u32 s52, s3, 4
    v_and_b32 v1, 15, v0
    v_lshrrev_b32 v2, 4, v0
    s_mov_b32 s47, 0x20000
    s_lshl_b32 s7, s5, 20
    s_lshl_b32 s9, s52, 18
    s_add_u32 s7, s7, s9
    s_lshl_b32 s9, s4, 8
    s_add_u32 s7, s7, s9
    v_lshrrev_b32 v20, 2, v1
    v_lshlrev_b32 v20, 11, v20
    v_lshl_add_u32 v20, v2, 4, v20
    s_lshl_b32 s9, s5, 8
    s_lshl_b32 s10, s52, 6
    s_add_u32 s9, s9, s10
    v_add_u32 v20, s9, v20
    v_lshlrev_b32 v21, 4, v0
    s_lshl_b32 s9, s11, 2
    s_add_u32 s9, s9, s52
    s_lshl_b32 s9, s9, 9
    s_add_u32 s9, s9, 8912896
    v_add_u32 v24, s9, v21
    s_lshl_b32 s9, s11, 7
    s_add_u32 s9, s9, 8650752
    v_writelane_b32 v24, s9, 32
    s_mul_i32 s9, s4, 4352
    s_add_u32 s9, s9, 8454144
    s_mul_i32 s8, s52, 1088
    s_add_u32 s9, s9, s8
    v_writelane_b32 v24, s9, 33
    v_mov_b32 v28, -1
    s_add_u32 s9, s52, 1120
    v_writelane_b32 v28, s9, 33
    v_mov_b32 v29, -1
    v_mov_b32 v30, -1
    v_mov_b32 v31, -1
    s_cmp_eq_u32 s5, 0
    s_cselect_b32 s8, 2, 0
    s_cmp_eq_u32 s52, 0
    s_cselect_b32 s9, 1, 0
    s_or_b32 s8, s8, s9
    s_mov_b32 exec_hi, s8
    s_waitcnt lgkmcnt(0)
    global_store_dwordx4 v24, v[28:31], s[42:43] sc1
    s_mov_b64 exec, 1
    global_load_dword v196, v21, s[40:41] sc1
    s_mov_b64 exec, -1
    s_add_u32 s44, s22, s7
    s_addc_u32 s45, s23, 0
    s_mov_b32 s46, 254208
    v_mul_u32_u24 v3, 65536, v2
    v_lshl_add_u32 v3, v1, 4, v3
    buffer_load_dwordx4 v[32:35], v3, s[44:47], 0 offen nt
    s_mov_b32 s8, 8192
    buffer_load_dwordx4 v[36:39], v3, s[44:47], s8 offen nt
    s_mov_b32 s8, 16384
    buffer_load_dwordx4 v[40:43], v3, s[44:47], s8 offen nt
    s_mov_b32 s8, 24576
    buffer_load_dwordx4 v[44:47], v3, s[44:47], s8 offen nt
    s_mov_b32 s8, 32768
    buffer_load_dwordx4 v[48:51], v3, s[44:47], s8 offen nt
    s_mov_b32 s8, 40960
    buffer_load_dwordx4 v[52:55], v3, s[44:47], s8 offen nt
    s_mov_b32 s8, 49152
    buffer_load_dwordx4 v[56:59], v3, s[44:47], s8 offen nt
    s_mov_b32 s8, 57344
    buffer_load_dwordx4 v[60:63], v3, s[44:47], s8 offen nt
    global_load_dwordx4 v[4:7], v20, s[16:17]
    s_mov_b32 s48, s42
    s_mov_b32 s49, s43
    s_mov_b32 s50, 9437184
    s_mov_b32 s51, 0x20000
    s_lshl_b32 s68, s11, 2
    s_add_u32 s68, s68, s52
    s_lshl_b32 s68, s68, 9
    s_add_u32 s68, s68, 8912896
    s_lshl_b32 s71, s6, 3
    s_add_u32 s71, s71, s5
    s_lshl_b32 s71, s71, 2
    s_add_u32 s71, s71, s52
    s_lshl_b32 s71, s71, 10
    s_add_u32 s71, s71, 524288
    s_lshl_b32 s69, s11, 7
    s_add_u32 s69, s69, 8650752
    v_and_b32 v23, 31, v0
    v_mov_b32 v28, 0
    v_mov_b32 v29, 0
    v_mov_b32 v30, 0
    v_mov_b32 v31, 0
    v_mov_b32 v20, 18432
    s_cmp_lg_u32 s52, 0
    s_cbranch_scc1 L_noinit
    ds_write_b128 v20, v[28:31]
L_noinit:
    s_mov_b32 s54, 0x05040100
    s_mov_b32 s55, 0x07060302
    s_lshl_b32 s7, s52, 11
    v_lshlrev_b32 v8, 5, v0
    v_add_u32 v8, s7, v8
    s_lshl_b32 s7, s52, 9
    v_lshrrev_b32 v9, 5, v0
    v_lshlrev_b32 v9, 13, v9
    v_lshl_add_u32 v9, v23, 4, v9
    v_add_u32 v9, s7, v9
    v_lshlrev_b32 v10, 4, v0
    s_and_b32 s7, s4, 7
    s_lshr_b32 s8, s4, 3
    s_lshl_b32 s8, s8, 4
    s_add_u32 s7, s7, s8
    s_lshl_b32 s67, s7, 2
    s_waitcnt lgkmcnt(0)
    s_barrier
    s_waitcnt vmcnt(10)
    v_mov_b32 v20, 18436
    v_mov_b32 v21, 1
    s_mov_b64 exec, 1
    ds_add_rtn_u32 v21, v20, v21
    s_mov_b64 exec, -1
    s_waitcnt lgkmcnt(0)
    v_readfirstlane_b32 s70, v21
    v_mov_b32 v20, s67
    v_mov_b32 v195, 1
    s_cmp_lg_u32 s70, 3
    s_cbranch_scc1 L_notlast
    s_mov_b64 exec, 1
    global_atomic_add v195, v20, v195, s[40:41] sc0
    s_mov_b64 exec, -1
    s_waitcnt vmcnt(1)
    s_branch L_wq
L_notlast:
    s_waitcnt vmcnt(0)
L_wq:
    v_perm_b32 v96, v36, v32, s54
    v_perm_b32 v97, v44, v40, s54
    v_perm_b32 v98, v52, v48, s54
    v_perm_b32 v99, v60, v56, s54
    v_perm_b32 v100, v36, v32, s55
    v_perm_b32 v101, v44, v40, s55
    v_perm_b32 v102, v52, v48, s55
    v_perm_b32 v103, v60, v56, s55
    v_perm_b32 v104, v37, v33, s54
    v_perm_b32 v105, v45, v41, s54
    v_perm_b32 v106, v53, v49, s54
    v_perm_b32 v107, v61, v57, s54
    v_perm_b32 v108, v37, v33, s55
    v_perm_b32 v109, v45, v41, s55
    v_perm_b32 v110, v53, v49, s55
    v_perm_b32 v111, v61, v57, s55
    v_perm_b32 v112, v38, v34, s54
    v_perm_b32 v113, v46, v42, s54
    v_perm_b32 v114, v54, v50, s54
    v_perm_b32 v115, v62, v58, s54
    v_perm_b32 v116, v38, v34, s55
    v_perm_b32 v117, v46, v42, s55
    v_perm_b32 v118, v54, v50, s55
    v_perm_b32 v119, v62, v58, s55
    v_perm_b32 v120, v39, v35, s54
    v_perm_b32 v121, v47, v43, s54
    v_perm_b32 v122, v55, v51, s54
    v_perm_b32 v123, v63, v59, s54
    v_perm_b32 v124, v39, v35, s55
    v_perm_b32 v125, v47, v43, s55
    v_perm_b32 v126, v55, v51, s55
    v_perm_b32 v127, v63, v59, s55
    s_nop 1
    v_mfma_f32_16x16x32_bf16 v[128:131], v[4:7], v[96:99], 0
    v_mfma_f32_16x16x32_bf16 v[132:135], v[4:7], v[100:103], 0
    v_mfma_f32_16x16x32_bf16 v[136:139], v[4:7], v[104:107], 0
    v_mfma_f32_16x16x32_bf16 v[140:143], v[4:7], v[108:111], 0
    v_mfma_f32_16x16x32_bf16 v[144:147], v[4:7], v[112:115], 0
    v_mfma_f32_16x16x32_bf16 v[148:151], v[4:7], v[116:119], 0
    v_mfma_f32_16x16x32_bf16 v[152:155], v[4:7], v[120:123], 0
    v_mfma_f32_16x16x32_bf16 v[156:159], v[4:7], v[124:127], 0
    s_nop 1
    v_min_u32 v12, 0xfffffffe, v128
    v_min_u32 v13, 0xfffffffe, v132
    v_min_u32 v14, 0xfffffffe, v136
    v_min_u32 v15, 0xfffffffe, v140
    v_min_u32 v16, 0xfffffffe, v144
    v_min_u32 v17, 0xfffffffe, v148
    v_min_u32 v18, 0xfffffffe, v152
    s_nop 0
    v_min_u32 v19, 0xfffffffe, v156
    ds_write_b128 v8, v[12:15] offset:0
    ds_write_b128 v8, v[16:19] offset:16
    s_cmp_lg_u32 s70, 3
    s_cbranch_scc1 L_nobc
    s_waitcnt vmcnt(0)
    v_readfirstlane_b32 s8, v195
    v_lshlrev_b32 v22, 7, v0
    s_lshl_b32 s7, s4, 10
    s_add_u32 s7, s7, 8650752
    s_cmp_lg_u32 s8, 7
    s_cbranch_scc1 L_nobc
    s_mov_b64 exec, 0xff
    buffer_store_dword v22, v22, s[48:51], s7 offen sc1
    s_mov_b64 exec, -1
L_nobc:
    s_waitcnt lgkmcnt(0)
    v_mov_b32 v20, 18432
    v_mov_b32 v21, 1
    s_mov_b64 exec, 1
    ds_add_u32 v20, v21
    s_mov_b64 exec, -1
    v_mov_b32 v20, 18432
    s_mov_b32 s53, 2097152
Llw_1:
    ds_read_b32 v21, v20
    s_waitcnt lgkmcnt(0)
    v_readfirstlane_b32 s8, v21
    s_cmp_ge_u32 s8, 4
    s_cbranch_scc1 Llwd_2
    s_sub_u32 s53, s53, 1
    s_cbranch_scc1 Llwd_2
    s_branch Llw_1
Llwd_2:
    ds_read_b128 v[128:131], v9 offset:0
    ds_read_b128 v[132:135], v9 offset:2048
    ds_read_b128 v[136:139], v9 offset:4096
    ds_read_b128 v[140:143], v9 offset:6144
    s_waitcnt lgkmcnt(0)
    v_pk_add_f32 v[128:129], v[128:129], v[132:133]
    v_pk_add_f32 v[136:137], v[136:137], v[140:141]
    v_pk_add_f32 v[130:131], v[130:131], v[134:135]
    v_pk_add_f32 v[138:139], v[138:139], v[142:143]
    v_pk_add_f32 v[128:129], v[128:129], v[136:137]
    v_pk_add_f32 v[130:131], v[130:131], v[138:139]
    s_nop 0
    v_min_u32 v128, 0xfffffffe, v128
    s_mov_b32 exec_hi, 0
    buffer_store_dwordx4 v[128:131], v10, s[48:51], s68 offen sc1
    s_mov_b64 exec, -1
    v_lshrrev_b32 v22, 5, v0
    v_lshlrev_b32 v23, 11, v22
    v_and_b32 v24, 31, v0
    v_lshl_add_u32 v23, v24, 4, v23
    v_lshlrev_b32 v24, 3, v24
    v_lshl_add_u32 v24, v22, 2, v24
    s_lshl_b32 s7, s52, 8
    v_add_u32 v24, s7, v24
    s_lshl_b32 s10, s4, 14
    s_lshl_b32 s9, s52, 9
    s_add_u32 s10, s10, s9
    s_add_u32 s10, s10, 8912896
    s_mov_b32 s53, 262144
    s_mov_b32 s53, 262144
Lmb_3:
    buffer_load_dword v20, off, s[48:51], s69 offset:0 sc1
    s_waitcnt vmcnt(0)
    v_readfirstlane_b32 s8, v20
    s_cmp_lg_u32 s8, -1
    s_cbranch_scc1 Lmbd_4
    s_sleep 1
    s_sub_u32 s53, s53, 1
    s_cbranch_scc0 Lmb_3
Lmbd_4:
L_mbok:
L_qretry:
    s_mov_b32 s7, s10
    buffer_load_dwordx4 v[128:131], v23, s[48:51], s7 offen sc1
    s_add_u32 s7, s7, 4096
    buffer_load_dwordx4 v[132:135], v23, s[48:51], s7 offen sc1
    s_add_u32 s7, s7, 4096
    buffer_load_dwordx4 v[136:139], v23, s[48:51], s7 offen sc1
    s_add_u32 s7, s7, 4096
    buffer_load_dwordx4 v[140:143], v23, s[48:51], s7 offen sc1
    s_waitcnt vmcnt(0)
    v_max3_u32 v20, v128, v132, v136
    v_max_u32 v20, v20, v140
    v_cmp_eq_u32 vcc, -1, v20
    s_cbranch_vccz L_qok
    s_sleep 1
    s_sub_u32 s53, s53, 1
    s_cbranch_scc0 L_qretry
L_qok:
    v_pk_add_f32 v[128:129], v[128:129], v[132:133]
    v_pk_add_f32 v[136:137], v[136:137], v[140:141]
    v_pk_add_f32 v[130:131], v[130:131], v[134:135]
    v_pk_add_f32 v[138:139], v[138:139], v[142:143]
    v_pk_add_f32 v[128:129], v[128:129], v[136:137]
    v_pk_add_f32 v[130:131], v[130:131], v[138:139]
    s_nop 1
    v_permlane32_swap_b32 v128, v130
    v_permlane32_swap_b32 v129, v131
    s_nop 0
    v_add_f32 v128, v128, v130
    v_add_f32 v129, v129, v131
    v_cvt_pk_bf16_f32 v128, v128, v129
    ds_write_b32 v24, v128 offset:16384
    s_waitcnt lgkmcnt(0)
    s_barrier
    v_mov_b32 v28, -1
    v_mov_b32 v29, -1
    v_mov_b32 v30, -1
    v_mov_b32 v31, -1
    s_lshl_b32 s7, s5, 7
    v_lshl_add_u32 v199, v1, 4, s7
    s_lshl_b32 s7, s5, 4
    s_add_u32 s7, s7, 1024
    v_mov_b32 v22, s7
    v_cmp_lt_u32 vcc, 7, v1
    s_lshl_b32 s64, s4, 15
    s_lshl_b32 s7, s52, 11
    v_cndmask_b32 v199, v199, v22, vcc
    s_add_u32 s64, s64, s7
    s_add_u32 s64, s64, 6291456
    v_lshl_add_u32 v22, v2, 13, v199
    s_mov_b32 exec_lo, 0x01ff01ff
    s_mov_b32 exec_hi, 0x01ff01ff
    buffer_store_dwordx4 v[28:31], v22, s[48:51], s64 offen sc1
    s_mov_b64 exec, -1
    s_lshl_b32 s66, s5, 5
    s_add_u32 s66, s66, s4
    s_lshl_b32 s66, s66, 9
    s_lshl_b32 s7, s52, 7
    s_add_u32 s66, s66, s7
    s_add_u32 s66, s66, 4194304
    v_lshlrev_b32 v22, 17, v2
    v_lshl_add_u32 v22, v1, 4, v22
    s_mov_b32 exec_lo, 0x00ff00ff
    s_mov_b32 exec_hi, 0x00ff00ff
    buffer_store_dwordx4 v[28:31], v22, s[48:51], s66 offen sc1
    s_mov_b64 exec, -1
    buffer_store_dwordx4 v[28:31], v10, s[48:51], s71 offen sc1
    s_and_b32 s9, s5, 1
    s_lshl_b32 s9, s9, 2
    s_add_u32 s76, s9, s52
    s_lshl_b32 s76, s76, 7
    s_lshl_b32 s10, s6, 2
    s_add_u32 s76, s76, s10
    s_lshr_b32 s10, s5, 1
    s_add_u32 s76, s76, s10
    s_lshl_b32 s76, s76, 9
    v_lshrrev_b32 v22, 5, v0
    v_lshlrev_b32 v22, 19, v22
    v_and_b32 v23, 31, v0
    v_lshl_add_u32 v22, v23, 4, v22
    s_add_u32 s8, s76, 2097152
    buffer_store_dwordx4 v[28:31], v22, s[48:51], s8 offen sc1
    s_add_u32 s8, s76, 3145728
    buffer_store_dwordx4 v[28:31], v22, s[48:51], s8 offen sc1
    s_lshl_b32 s7, s52, 13
    s_add_u32 s7, s7, 28672
    v_add_u32 v3, s7, v10
    s_cmp_ge_u32 s6, 28
    s_cbranch_scc1 L_nomlp1
    ds_read_b128 v[32:35], v3 offset:0
    ds_read_b128 v[36:39], v3 offset:1024
    ds_read_b128 v[40:43], v3 offset:2048
    ds_read_b128 v[44:47], v3 offset:3072
    ds_read_b128 v[48:51], v3 offset:4096
    ds_read_b128 v[52:55], v3 offset:5120
    ds_read_b128 v[56:59], v3 offset:6144
    ds_read_b128 v[60:63], v3 offset:7168
    ds_read_b128 v[64:67], v3 offset:32768
    ds_read_b128 v[68:71], v3 offset:33792
    ds_read_b128 v[72:75], v3 offset:34816
    ds_read_b128 v[76:79], v3 offset:35840
    ds_read_b128 v[80:83], v3 offset:36864
    ds_read_b128 v[84:87], v3 offset:37888
    ds_read_b128 v[88:91], v3 offset:38912
    ds_read_b128 v[92:95], v3 offset:39936
    v_add_u32 v3, 0x10000, v3
    s_waitcnt lgkmcnt(8)
    v_perm_b32 v96, v36, v32, s54
    v_perm_b32 v97, v44, v40, s54
    v_perm_b32 v98, v52, v48, s54
    v_perm_b32 v99, v60, v56, s54
    v_perm_b32 v100, v36, v32, s55
    v_perm_b32 v101, v44, v40, s55
    v_perm_b32 v102, v52, v48, s55
    v_perm_b32 v103, v60, v56, s55
    v_perm_b32 v104, v37, v33, s54
    v_perm_b32 v105, v45, v41, s54
    v_perm_b32 v106, v53, v49, s54
    v_perm_b32 v107, v61, v57, s54
    v_perm_b32 v108, v37, v33, s55
    v_perm_b32 v109, v45, v41, s55
    v_perm_b32 v110, v53, v49, s55
    v_perm_b32 v111, v61, v57, s55
    v_perm_b32 v112, v38, v34, s54
    v_perm_b32 v113, v46, v42, s54
    v_perm_b32 v114, v54, v50, s54
    v_perm_b32 v115, v62, v58, s54
    v_perm_b32 v116, v38, v34, s55
    v_perm_b32 v117, v46, v42, s55
    v_perm_b32 v118, v54, v50, s55
    v_perm_b32 v119, v62, v58, s55
    v_perm_b32 v120, v39, v35, s54
    v_perm_b32 v121, v47, v43, s54
    v_perm_b32 v122, v55, v51, s54
    v_perm_b32 v123, v63, v59, s54
    v_perm_b32 v124, v39, v35, s55
    v_perm_b32 v125, v47, v43, s55
    v_perm_b32 v126, v55, v51, s55
    v_perm_b32 v127, v63, v59, s55
    s_nop 1
    v_mfma_f32_16x16x32_bf16 v[128:131], v[4:7], v[96:99], 0
    v_mfma_f32_16x16x32_bf16 v[132:135], v[4:7], v[100:103], 0
    v_mfma_f32_16x16x32_bf16 v[136:139], v[4:7], v[104:107], 0
    v_mfma_f32_16x16x32_bf16 v[140:143], v[4:7], v[108:111], 0
    v_mfma_f32_16x16x32_bf16 v[144:147], v[4:7], v[112:115], 0
    v_mfma_f32_16x16x32_bf16 v[148:151], v[4:7], v[116:119], 0
    v_mfma_f32_16x16x32_bf16 v[152:155], v[4:7], v[120:123], 0
    v_mfma_f32_16x16x32_bf16 v[156:159], v[4:7], v[124:127], 0
    s_nop 1
    v_min_u32 v12, 0xfffffffe, v128
    v_min_u32 v13, 0xfffffffe, v132
    v_min_u32 v14, 0xfffffffe, v136
    v_min_u32 v15, 0xfffffffe, v140
    v_min_u32 v16, 0xfffffffe, v144
    v_min_u32 v17, 0xfffffffe, v148
    v_min_u32 v18, 0xfffffffe, v152
    s_nop 0
    v_min_u32 v19, 0xfffffffe, v156
    ds_write_b128 v8, v[12:15] offset:0
    ds_write_b128 v8, v[16:19] offset:16
    ds_read_b128 v[32:35], v3 offset:0
    ds_read_b128 v[36:39], v3 offset:1024
    ds_read_b128 v[40:43], v3 offset:2048
    ds_read_b128 v[44:47], v3 offset:3072
    ds_read_b128 v[48:51], v3 offset:4096
    ds_read_b128 v[52:55], v3 offset:5120
    ds_read_b128 v[56:59], v3 offset:6144
    ds_read_b128 v[60:63], v3 offset:7168
    s_waitcnt vmcnt(0)
    v_mov_b32 v20, 18436
    v_mov_b32 v21, 1
    s_mov_b64 exec, 1
    ds_add_rtn_u32 v21, v20, v21
    s_mov_b64 exec, -1
    s_waitcnt lgkmcnt(0)
    v_readfirstlane_b32 s70, v21
    v_mov_b32 v20, s67
    v_mov_b32 v195, 0x100
    s_cmp_lg_u32 s70, 7
    s_cbranch_scc1 Lar_5
    s_mov_b64 exec, 1
    global_atomic_add v195, v20, v195, s[40:41] sc0
    s_mov_b64 exec, -1
Lar_5:
    v_perm_b32 v96, v68, v64, s54
    v_perm_b32 v97, v76, v72, s54
    v_perm_b32 v98, v84, v80, s54
    v_perm_b32 v99, v92, v88, s54
    v_perm_b32 v100, v68, v64, s55
    v_perm_b32 v101, v76, v72, s55
    v_perm_b32 v102, v84, v80, s55
    v_perm_b32 v103, v92, v88, s55
    v_perm_b32 v104, v69, v65, s54
    v_perm_b32 v105, v77, v73, s54
    v_perm_b32 v106, v85, v81, s54
    v_perm_b32 v107, v93, v89, s54
    v_perm_b32 v108, v69, v65, s55
    v_perm_b32 v109, v77, v73, s55
    v_perm_b32 v110, v85, v81, s55
    v_perm_b32 v111, v93, v89, s55
    v_perm_b32 v112, v70, v66, s54
    v_perm_b32 v113, v78, v74, s54
    v_perm_b32 v114, v86, v82, s54
    v_perm_b32 v115, v94, v90, s54
    v_perm_b32 v116, v70, v66, s55
    v_perm_b32 v117, v78, v74, s55
    v_perm_b32 v118, v86, v82, s55
    v_perm_b32 v119, v94, v90, s55
    v_perm_b32 v120, v71, v67, s54
    v_perm_b32 v121, v79, v75, s54
    v_perm_b32 v122, v87, v83, s54
    v_perm_b32 v123, v95, v91, s54
    v_perm_b32 v124, v71, v67, s55
    v_perm_b32 v125, v79, v75, s55
    v_perm_b32 v126, v87, v83, s55
    v_perm_b32 v127, v95, v91, s55
    s_nop 1
    v_mfma_f32_16x16x32_bf16 v[128:131], v[4:7], v[96:99], 0
    v_mfma_f32_16x16x32_bf16 v[132:135], v[4:7], v[100:103], 0
    v_mfma_f32_16x16x32_bf16 v[136:139], v[4:7], v[104:107], 0
    v_mfma_f32_16x16x32_bf16 v[140:143], v[4:7], v[108:111], 0
    v_mfma_f32_16x16x32_bf16 v[144:147], v[4:7], v[112:115], 0
    v_mfma_f32_16x16x32_bf16 v[148:151], v[4:7], v[116:119], 0
    v_mfma_f32_16x16x32_bf16 v[152:155], v[4:7], v[120:123], 0
    v_mfma_f32_16x16x32_bf16 v[156:159], v[4:7], v[124:127], 0
    s_nop 1
    v_min_u32 v12, 0xfffffffe, v128
    v_min_u32 v13, 0xfffffffe, v132
    v_min_u32 v14, 0xfffffffe, v136
    v_min_u32 v15, 0xfffffffe, v140
    v_min_u32 v16, 0xfffffffe, v144
    v_min_u32 v17, 0xfffffffe, v148
    v_min_u32 v18, 0xfffffffe, v152
    s_nop 0
    v_min_u32 v19, 0xfffffffe, v156
    ds_write_b128 v8, v[12:15] offset:8192
    ds_write_b128 v8, v[16:19] offset:8208
    s_waitcnt lgkmcnt(0)
    v_mov_b32 v20, 18432
    v_mov_b32 v21, 1
    s_mov_b64 exec, 1
    ds_add_u32 v20, v21
    s_mov_b64 exec, -1
    v_mov_b32 v20, 18432
    s_mov_b32 s53, 2097152
Llw_6:
    ds_read_b32 v21, v20
    s_waitcnt lgkmcnt(0)
    v_readfirstlane_b32 s8, v21
    s_cmp_ge_u32 s8, 8
    s_cbranch_scc1 Llwd_7
    s_sub_u32 s53, s53, 1
    s_cbranch_scc1 Llwd_7
    s_branch Llw_6
Llwd_7:
    ds_read_b128 v[128:131], v9 offset:0
    ds_read_b128 v[132:135], v9 offset:2048
    ds_read_b128 v[136:139], v9 offset:4096
    ds_read_b128 v[140:143], v9 offset:6144
    s_waitcnt lgkmcnt(0)
    v_pk_add_f32 v[128:129], v[128:129], v[132:133]
    v_pk_add_f32 v[136:137], v[136:137], v[140:141]
    v_pk_add_f32 v[130:131], v[130:131], v[134:135]
    v_pk_add_f32 v[138:139], v[138:139], v[142:143]
    v_pk_add_f32 v[128:129], v[128:129], v[136:137]
    v_pk_add_f32 v[130:131], v[130:131], v[138:139]
    s_nop 0
    v_min_u32 v128, 0xfffffffe, v128
    s_nop 0
    buffer_store_dwordx4 v[128:131], v10, s[48:51], s71 offen sc1
    s_waitcnt vmcnt(1)
    s_cmp_lg_u32 s70, 7
    s_cbranch_scc1 Larb_8
    s_waitcnt vmcnt(0)
    v_readfirstlane_b32 s8, v195
    v_mov_b32 v20, 32
    v_mov_b32 v195, 1
    s_lshr_b32 s8, s8, 8
    s_cmp_lg_u32 s8, 7
    s_cbranch_scc1 Larb_8
    s_mov_b64 exec, 1
    global_atomic_add v195, v20, v195, s[40:41] sc0
    s_mov_b64 exec, -1
    s_waitcnt vmcnt(0)
    v_readfirstlane_b32 s8, v195
    v_lshlrev_b32 v20, 7, v0
    s_cmp_lg_u32 s8, 31
    s_cbranch_scc1 Larb_8
    s_mov_b32 s8, 8650752
    buffer_store_dword v20, v20, s[48:51], s8 offen offset:4 sc1
    s_mov_b32 s8, 8658944
    buffer_store_dword v20, v20, s[48:51], s8 offen offset:4 sc1
    s_mov_b32 s8, 8667136
    buffer_store_dword v20, v20, s[48:51], s8 offen offset:4 sc1
    s_mov_b32 s8, 8675328
    buffer_store_dword v20, v20, s[48:51], s8 offen offset:4 sc1
Larb_8:
    v_perm_b32 v96, v36, v32, s54
    v_perm_b32 v97, v44, v40, s54
    v_perm_b32 v98, v52, v48, s54
    v_perm_b32 v99, v60, v56, s54
    v_perm_b32 v100, v36, v32, s55
    v_perm_b32 v101, v44, v40, s55
    v_perm_b32 v102, v52, v48, s55
    v_perm_b32 v103, v60, v56, s55
    v_perm_b32 v104, v37, v33, s54
    v_perm_b32 v105, v45, v41, s54
    v_perm_b32 v106, v53, v49, s54
    v_perm_b32 v107, v61, v57, s54
    v_perm_b32 v108, v37, v33, s55
    v_perm_b32 v109, v45, v41, s55
    v_perm_b32 v110, v53, v49, s55
    v_perm_b32 v111, v61, v57, s55
    v_perm_b32 v112, v38, v34, s54
    v_perm_b32 v113, v46, v42, s54
    v_perm_b32 v114, v54, v50, s54
    v_perm_b32 v115, v62, v58, s54
    v_perm_b32 v116, v38, v34, s55
    v_perm_b32 v117, v46, v42, s55
    v_perm_b32 v118, v54, v50, s55
    v_perm_b32 v119, v62, v58, s55
    v_perm_b32 v120, v39, v35, s54
    v_perm_b32 v121, v47, v43, s54
    v_perm_b32 v122, v55, v51, s54
    v_perm_b32 v123, v63, v59, s54
    v_perm_b32 v124, v39, v35, s55
    v_perm_b32 v125, v47, v43, s55
    v_perm_b32 v126, v55, v51, s55
    v_perm_b32 v127, v63, v59, s55
    v_lshrrev_b32 v22, 3, v0
    v_lshlrev_b32 v22, 12, v22
    v_and_b32 v23, 7, v0
    v_lshl_add_u32 v22, v23, 4, v22
    v_lshlrev_b32 v23, 3, v23
    v_lshl_add_u32 v23, v2, 1, v23
    s_lshl_b32 s7, s52, 6
    v_add_u32 v23, s7, v23
    s_lshl_b32 s7, s6, 15
    s_lshl_b32 s9, s52, 10
    s_add_u32 s7, s7, s9
    s_lshr_b32 s9, s5, 1
    s_lshl_b32 s9, s9, 7
    s_add_u32 s7, s7, s9
    s_add_u32 s7, s7, 524288
    s_mov_b32 s53, 262144
Lmb_9:
    buffer_load_dword v20, off, s[48:51], s69 offset:4 sc1
    s_waitcnt vmcnt(0)
    v_readfirstlane_b32 s8, v20
    s_cmp_lg_u32 s8, -1
    s_cbranch_scc1 Lmbd_10
    s_sleep 16
    s_sub_u32 s53, s53, 1
    s_cbranch_scc0 Lmb_9
Lmbd_10:
    s_mov_b32 s53, 262144
L_hretry:
    buffer_load_dwordx4 v[128:131], v22, s[48:51], s7 offen sc1
    buffer_load_dwordx4 v[132:135], v22, s[48:51], s7 offen offset:512 sc1
    s_waitcnt vmcnt(0)
    v_max_u32 v20, v128, v132
    v_cmp_eq_u32 vcc, -1, v20
    s_cbranch_vccz L_hok
    s_sleep 16
    s_sub_u32 s53, s53, 1
    s_cbranch_scc0 L_hretry
L_hok:
    s_nop 0
    v_permlane32_swap_b32 v128, v130
    v_permlane32_swap_b32 v129, v131
    v_permlane32_swap_b32 v132, v134
    v_permlane32_swap_b32 v133, v135
    s_nop 0
    v_add_f32 v128, v128, v130
    v_add_f32 v129, v129, v131
    v_add_f32 v132, v132, v134
    v_add_f32 v133, v133, v135
    s_nop 1
    v_permlane16_swap_b32 v128, v129
    v_permlane16_swap_b32 v132, v133
    s_nop 0
    v_add_f32 v128, v128, v129
    v_add_f32 v132, v132, v133
    s_nop 1
    v_add_f32_dpp v128, v128, v128 row_ror:8 row_mask:0xf bank_mask:0xf
    v_add_f32_dpp v132, v132, v132 row_ror:8 row_mask:0xf bank_mask:0xf
    v_cvt_pk_bf16_f32 v128, v128, v128
    v_and_b32 v128, 0xffff0000, v128
    v_cvt_pk_bf16_f32 v132, v132, v132
    v_and_b32 v132, 0xffff0000, v132
    v_mov_b32 v129, v128
    v_mul_f32 v129, 0xbfb8aa3b, v129
    v_exp_f32 v129, v129
    s_nop 0
    v_add_f32 v129, 1.0, v129
    v_rcp_f32 v129, v129
    s_nop 0
    v_mul_f32 v128, v128, v129
    v_cvt_pk_bf16_f32 v128, v128, v128
    v_and_b32 v128, 0xffff0000, v128
    v_mul_f32 v128, v128, v132
    v_cvt_pk_bf16_f32 v128, v128, v128
    ds_write_b16 v23, v128 offset:17408
    s_waitcnt lgkmcnt(0)
    v_mov_b32 v20, 18432
    v_mov_b32 v21, 1
    s_mov_b64 exec, 1
    ds_add_u32 v20, v21
    s_mov_b64 exec, -1
    v_mov_b32 v20, 18432
    s_mov_b32 s53, 2097152
Llw_11:
    ds_read_b32 v21, v20
    s_waitcnt lgkmcnt(0)
    v_readfirstlane_b32 s8, v21
    s_cmp_ge_u32 s8, 12
    s_cbranch_scc1 Llwd_12
    s_sub_u32 s53, s53, 1
    s_cbranch_scc1 Llwd_12
    s_branch Llw_11
Llwd_12:
    v_lshrrev_b32 v22, 2, v1
    v_lshlrev_b32 v22, 6, v22
    v_lshl_add_u32 v22, v2, 4, v22
    ds_read_b128 v[4:7], v22 offset:17408
    v_lshlrev_b32 v22, 19, v2
    v_lshl_add_u32 v22, v1, 5, v22
    s_add_u32 s7, s76, 2097152
    s_waitcnt lgkmcnt(0)
    s_nop 1
    v_mfma_f32_16x16x32_bf16 v[128:131], v[4:7], v[96:99], 0
    v_mfma_f32_16x16x32_bf16 v[132:135], v[4:7], v[100:103], 0
    v_mfma_f32_16x16x32_bf16 v[136:139], v[4:7], v[104:107], 0
    v_mfma_f32_16x16x32_bf16 v[140:143], v[4:7], v[108:111], 0
    v_mfma_f32_16x16x32_bf16 v[144:147], v[4:7], v[112:115], 0
    v_mfma_f32_16x16x32_bf16 v[148:151], v[4:7], v[116:119], 0
    v_mfma_f32_16x16x32_bf16 v[152:155], v[4:7], v[120:123], 0
    v_mfma_f32_16x16x32_bf16 v[156:159], v[4:7], v[124:127], 0
    s_nop 1
    v_min_u32 v12, 0xfffffffe, v128
    v_min_u32 v13, 0xfffffffe, v132
    v_min_u32 v14, 0xfffffffe, v136
    v_min_u32 v15, 0xfffffffe, v140
    v_min_u32 v16, 0xfffffffe, v144
    v_min_u32 v17, 0xfffffffe, v148
    v_min_u32 v18, 0xfffffffe, v152
    s_nop 0
    v_min_u32 v19, 0xfffffffe, v156
    buffer_store_dwordx4 v[12:15], v22, s[48:51], s7 offen sc1
    buffer_store_dwordx4 v[16:19], v22, s[48:51], s7 offen offset:16 sc1
    s_branch L_mlpdone
L_nomlp1:
    v_add_u32 v3, 0x10000, v3
    s_waitcnt vmcnt(0)
    v_mov_b32 v20, 18436
    v_mov_b32 v21, 1
    s_mov_b64 exec, 1
    ds_add_rtn_u32 v21, v20, v21
    s_mov_b64 exec, -1
    s_waitcnt lgkmcnt(0)
    v_readfirstlane_b32 s70, v21
    v_mov_b32 v20, s67
    v_mov_b32 v195, 0x100
    s_cmp_lg_u32 s70, 7
    s_cbranch_scc1 Lar_13
    s_mov_b64 exec, 1
    global_atomic_add v195, v20, v195, s[40:41] sc0
    s_mov_b64 exec, -1
Lar_13:
    s_waitcnt vmcnt(0)
    s_cmp_lg_u32 s70, 7
    s_cbranch_scc1 Larb_14
    s_waitcnt vmcnt(0)
    v_readfirstlane_b32 s8, v195
    v_mov_b32 v20, 32
    v_mov_b32 v195, 1
    s_lshr_b32 s8, s8, 8
    s_cmp_lg_u32 s8, 7
    s_cbranch_scc1 Larb_14
    s_mov_b64 exec, 1
    global_atomic_add v195, v20, v195, s[40:41] sc0
    s_mov_b64 exec, -1
    s_waitcnt vmcnt(0)
    v_readfirstlane_b32 s8, v195
    v_lshlrev_b32 v20, 7, v0
    s_cmp_lg_u32 s8, 31
    s_cbranch_scc1 Larb_14
    s_mov_b32 s8, 8650752
    buffer_store_dword v20, v20, s[48:51], s8 offen offset:4 sc1
    s_mov_b32 s8, 8658944
    buffer_store_dword v20, v20, s[48:51], s8 offen offset:4 sc1
    s_mov_b32 s8, 8667136
    buffer_store_dword v20, v20, s[48:51], s8 offen offset:4 sc1
    s_mov_b32 s8, 8675328
    buffer_store_dword v20, v20, s[48:51], s8 offen offset:4 sc1
Larb_14:
L_nomlp2:
    s_mov_b32 s53, 262144
Lmb_15:
    buffer_load_dword v20, off, s[48:51], s69 offset:4 sc1
    s_waitcnt vmcnt(0)
    v_readfirstlane_b32 s8, v20
    s_cmp_lg_u32 s8, -1
    s_cbranch_scc1 Lmbd_16
    s_sleep 16
    s_sub_u32 s53, s53, 1
    s_cbranch_scc0 Lmb_15
Lmbd_16:
L_mlpdone:
    v_lshrrev_b32 v195, 1, v1
    v_lshlrev_b32 v196, 4, v195
    v_lshlrev_b32 v195, 7, v195
    v_lshl_add_u32 v195, v2, 5, v195
    v_and_b32 v20, 1, v0
    v_lshl_add_u32 v195, v20, 4, v195
    v_and_b32 v20, 7, v0
    v_lshlrev_b32 v197, 4, v20
    s_lshl_b32 s7, s52, 7
    v_add_u32 v202, s7, v197
    v_add_u32 v200, 20480, v202
    s_lshl_b32 s7, s52, 9
    v_lshl_add_u32 v201, v1, 5, s7
    s_mov_b32 s65, 18688
    s_mov_b32 s56, 0
    s_mov_b32 s67, 4
    s_lshr_b32 s57, s4, 3
    s_mov_b32 s63, 0
    s_lshl_b32 s7, s57, 11
    v_lshlrev_b32 v20, 5, v0
    v_add_u32 v21, s7, v20
    v_and_b32 v22, 3, v0
    v_lshrrev_b32 v192, 2, v0
    v_lshlrev_b32 v192, 9, v192
    v_lshl_add_u32 v192, v22, 4, v192
    v_lshlrev_b32 v198, 2, v22
    v_add_u32 v198, v198, v2
    v_lshlrev_b32 v198, 1, v198
    s_lshl_b32 s8, s5, 8
    s_add_u32 s7, s7, s8
    s_and_b32 s8, s4, 7
    s_lshl_b32 s9, s8, 5
    s_add_u32 s7, s7, s9
    v_add_u32 v198, s7, v198
    s_lshl_b32 s58, s57, 3
    s_add_u32 s58, s58, s5
    s_lshl_b32 s77, s58, 14
    s_lshl_b32 s58, s58, 16
    s_lshl_b32 s8, s8, 6
    s_add_u32 s58, s58, s8
    s_add_u32 s58, s58, 2097152
    s_add_u32 s77, s77, s8
    s_add_u32 s77, s77, 4194304
    s_mov_b32 s59, 9437184
    s_cmp_lg_u32 s52, 0
    s_cbranch_scc1 L_pre
    global_load_dwordx4 v[32:35], v21, s[16:17]
    global_load_dwordx4 v[36:39], v21, s[16:17] offset:16
    global_load_dwordx4 v[40:43], v20, s[28:29]
    global_load_dwordx4 v[44:47], v20, s[28:29] offset:16
    global_load_dwordx4 v[48:51], v20, s[36:37]
    global_load_dwordx4 v[52:55], v20, s[36:37] offset:16
    global_load_ushort v194, v198, s[16:17]
    v_mov_b32 v22, 0
    v_mov_b32 v23, 0
    s_waitcnt vmcnt(0)
    v_lshlrev_b32 v194, 16, v194
    v_lshlrev_b32 v24, 16, v32
    v_and_b32 v25, 0xffff0000, v32
    v_lshlrev_b32 v26, 16, v40
    v_and_b32 v27, 0xffff0000, v40
    v_lshlrev_b32 v28, 16, v48
    v_and_b32 v29, 0xffff0000, v48
    v_fmac_f32 v22, v24, v26
    v_fmac_f32 v22, v25, v27
    v_mul_f32 v28, v24, v28
    v_mul_f32 v29, v25, v29
    v_cvt_pk_bf16_f32 v28, v28, v29
    v_lshlrev_b32 v29, 16, v28
    v_and_b32 v28, 0xffff0000, v28
    v_add_f32 v23, v23, v29
    v_add_f32 v23, v23, v28
    v_lshlrev_b32 v24, 16, v33
    v_and_b32 v25, 0xffff0000, v33
    v_lshlrev_b32 v26, 16, v41
    v_and_b32 v27, 0xffff0000, v41
    v_lshlrev_b32 v28, 16, v49
    v_and_b32 v29, 0xffff0000, v49
    v_fmac_f32 v22, v24, v26
    v_fmac_f32 v22, v25, v27
    v_mul_f32 v28, v24, v28
    v_mul_f32 v29, v25, v29
    v_cvt_pk_bf16_f32 v28, v28, v29
    v_lshlrev_b32 v29, 16, v28
    v_and_b32 v28, 0xffff0000, v28
    v_add_f32 v23, v23, v29
    v_add_f32 v23, v23, v28
    v_lshlrev_b32 v24, 16, v34
    v_and_b32 v25, 0xffff0000, v34
    v_lshlrev_b32 v26, 16, v42
    v_and_b32 v27, 0xffff0000, v42
    v_lshlrev_b32 v28, 16, v50
    v_and_b32 v29, 0xffff0000, v50
    v_fmac_f32 v22, v24, v26
    v_fmac_f32 v22, v25, v27
    v_mul_f32 v28, v24, v28
    v_mul_f32 v29, v25, v29
    v_cvt_pk_bf16_f32 v28, v28, v29
    v_lshlrev_b32 v29, 16, v28
    v_and_b32 v28, 0xffff0000, v28
    v_add_f32 v23, v23, v29
    v_add_f32 v23, v23, v28
    v_lshlrev_b32 v24, 16, v35
    v_and_b32 v25, 0xffff0000, v35
    v_lshlrev_b32 v26, 16, v43
    v_and_b32 v27, 0xffff0000, v43
    v_lshlrev_b32 v28, 16, v51
    v_and_b32 v29, 0xffff0000, v51
    v_fmac_f32 v22, v24, v26
    v_fmac_f32 v22, v25, v27
    v_mul_f32 v28, v24, v28
    v_mul_f32 v29, v25, v29
    v_cvt_pk_bf16_f32 v28, v28, v29
    v_lshlrev_b32 v29, 16, v28
    v_and_b32 v28, 0xffff0000, v28
    v_add_f32 v23, v23, v29
    v_add_f32 v23, v23, v28
    v_lshlrev_b32 v24, 16, v36
    v_and_b32 v25, 0xffff0000, v36
    v_lshlrev_b32 v26, 16, v44
    v_and_b32 v27, 0xffff0000, v44
    v_lshlrev_b32 v28, 16, v52
    v_and_b32 v29, 0xffff0000, v52
    v_fmac_f32 v22, v24, v26
    v_fmac_f32 v22, v25, v27
    v_mul_f32 v28, v24, v28
    v_mul_f32 v29, v25, v29
    v_cvt_pk_bf16_f32 v28, v28, v29
    v_lshlrev_b32 v29, 16, v28
    v_and_b32 v28, 0xffff0000, v28
    v_add_f32 v23, v23, v29
    v_add_f32 v23, v23, v28
    v_lshlrev_b32 v24, 16, v37
    v_and_b32 v25, 0xffff0000, v37
    v_lshlrev_b32 v26, 16, v45
    v_and_b32 v27, 0xffff0000, v45
    v_lshlrev_b32 v28, 16, v53
    v_and_b32 v29, 0xffff0000, v53
    v_fmac_f32 v22, v24, v26
    v_fmac_f32 v22, v25, v27
    v_mul_f32 v28, v24, v28
    v_mul_f32 v29, v25, v29
    v_cvt_pk_bf16_f32 v28, v28, v29
    v_lshlrev_b32 v29, 16, v28
    v_and_b32 v28, 0xffff0000, v28
    v_add_f32 v23, v23, v29
    v_add_f32 v23, v23, v28
    v_lshlrev_b32 v24, 16, v38
    v_and_b32 v25, 0xffff0000, v38
    v_lshlrev_b32 v26, 16, v46
    v_and_b32 v27, 0xffff0000, v46
    v_lshlrev_b32 v28, 16, v54
    v_and_b32 v29, 0xffff0000, v54
    v_fmac_f32 v22, v24, v26
    v_fmac_f32 v22, v25, v27
    v_mul_f32 v28, v24, v28
    v_mul_f32 v29, v25, v29
    v_cvt_pk_bf16_f32 v28, v28, v29
    v_lshlrev_b32 v29, 16, v28
    v_and_b32 v28, 0xffff0000, v28
    v_add_f32 v23, v23, v29
    v_add_f32 v23, v23, v28
    v_lshlrev_b32 v24, 16, v39
    v_and_b32 v25, 0xffff0000, v39
    v_lshlrev_b32 v26, 16, v47
    v_and_b32 v27, 0xffff0000, v47
    v_lshlrev_b32 v28, 16, v55
    v_and_b32 v29, 0xffff0000, v55
    v_fmac_f32 v22, v24, v26
    v_fmac_f32 v22, v25, v27
    v_mul_f32 v28, v24, v28
    v_mul_f32 v29, v25, v29
    v_cvt_pk_bf16_f32 v28, v28, v29
    v_lshlrev_b32 v29, 16, v28
    v_and_b32 v28, 0xffff0000, v28
    v_add_f32 v23, v23, v29
    v_add_f32 v23, v23, v28
    s_nop 1
    v_add_f32_dpp v22, v22, v22 row_ror:1 row_mask:0xf bank_mask:0xf
    v_add_f32_dpp v23, v23, v23 row_ror:1 row_mask:0xf bank_mask:0xf
    s_nop 1
    v_add_f32_dpp v22, v22, v22 row_ror:2 row_mask:0xf bank_mask:0xf
    v_add_f32_dpp v23, v23, v23 row_ror:2 row_mask:0xf bank_mask:0xf
    s_nop 1
    v_add_f32_dpp v22, v22, v22 row_ror:4 row_mask:0xf bank_mask:0xf
    v_add_f32_dpp v23, v23, v23 row_ror:4 row_mask:0xf bank_mask:0xf
    s_nop 1
    v_add_f32_dpp v22, v22, v22 row_ror:8 row_mask:0xf bank_mask:0xf
    v_add_f32_dpp v23, v23, v23 row_ror:8 row_mask:0xf bank_mask:0xf
    s_nop 1
    v_add_f32_dpp v22, v22, v22 row_bcast:15 row_mask:0xa bank_mask:0xf
    v_add_f32_dpp v23, v23, v23 row_bcast:15 row_mask:0xa bank_mask:0xf
    s_nop 1
    v_add_f32_dpp v22, v22, v22 row_bcast:31 row_mask:0xc bank_mask:0xf
    v_add_f32_dpp v23, v23, v23 row_bcast:31 row_mask:0xc bank_mask:0xf
    v_cvt_pk_bf16_f32 v22, v22, v22
    v_and_b32 v22, 0xffff0000, v22
    v_cvt_pk_bf16_f32 v23, v23, v23
    v_and_b32 v23, 0xffff0000, v23
    v_mul_f32 v22, 0xbfb8aa3b, v22
    v_exp_f32 v22, v22
    s_nop 0
    v_add_f32 v22, 1.0, v22
    v_rcp_f32 v22, v22
    s_nop 0
    v_mul_f32 v23, 0xbfb8aa3b, v23
    v_exp_f32 v23, v23
    s_nop 0
    v_add_f32 v23, 1.0, v23
    v_rcp_f32 v23, v23
    s_nop 0
    v_cvt_pk_bf16_f32 v22, v22, v22
    v_and_b32 v22, 0xffff0000, v22
    v_cvt_pk_bf16_f32 v23, v23, v23
    v_and_b32 v23, 0xffff0000, v23
    v_sub_f32 v24, 1.0, v23
    v_cvt_pk_bf16_f32 v24, v24, v24
    v_and_b32 v24, 0xffff0000, v24
    s_nop 0
    v_readlane_b32 s60, v22, 63
    v_readlane_b32 s61, v23, 63
    v_readlane_b32 s62, v24, 63
    s_max_u32 s57, s57, 1
L_pre:
    v_mov_b32 v212, -1
    v_mov_b32 v213, -1
    v_mov_b32 v214, -1
    v_mov_b32 v215, -1
    v_mov_b32 v216, -1
    v_mov_b32 v217, -1
    v_mov_b32 v218, -1
    v_mov_b32 v219, -1
    v_mov_b32 v20, 18444
    s_mov_b32 s53, 2097152
Llw_17:
    ds_read_b32 v21, v20
    s_waitcnt lgkmcnt(0)
    v_readfirstlane_b32 s8, v21
    s_cmp_ge_u32 s8, 4
    s_cbranch_scc1 Llwd_18
    s_sub_u32 s53, s53, 1
    s_cbranch_scc1 Llwd_18
    s_sleep 1
    s_branch Llw_17
Llwd_18:
    ds_read_b128 v[64:67], v3 offset:32768
    ds_read_b128 v[68:71], v3 offset:33792
    ds_read_b128 v[72:75], v3 offset:34816
    ds_read_b128 v[76:79], v3 offset:35840
    ds_read_b128 v[80:83], v3 offset:36864
    ds_read_b128 v[84:87], v3 offset:37888
    ds_read_b128 v[88:91], v3 offset:38912
    ds_read_b128 v[92:95], v3 offset:39936
    s_waitcnt lgkmcnt(0)
    v_perm_b32 v160, v68, v64, s54
    v_perm_b32 v161, v76, v72, s54
    v_perm_b32 v162, v84, v80, s54
    v_perm_b32 v163, v92, v88, s54
    v_perm_b32 v164, v68, v64, s55
    v_perm_b32 v165, v76, v72, s55
    v_perm_b32 v166, v84, v80, s55
    v_perm_b32 v167, v92, v88, s55
    v_perm_b32 v168, v69, v65, s54
    v_perm_b32 v169, v77, v73, s54
    v_perm_b32 v170, v85, v81, s54
    v_perm_b32 v171, v93, v89, s54
    v_perm_b32 v172, v69, v65, s55
    v_perm_b32 v173, v77, v73, s55
    v_perm_b32 v174, v85, v81, s55
    v_perm_b32 v175, v93, v89, s55
    v_perm_b32 v176, v70, v66, s54
    v_perm_b32 v177, v78, v74, s54
    v_perm_b32 v178, v86, v82, s54
    v_perm_b32 v179, v94, v90, s54
    v_perm_b32 v180, v70, v66, s55
    v_perm_b32 v181, v78, v74, s55
    v_perm_b32 v182, v86, v82, s55
    v_perm_b32 v183, v94, v90, s55
    v_perm_b32 v184, v71, v67, s54
    v_perm_b32 v185, v79, v75, s54
    v_perm_b32 v186, v87, v83, s54
    v_perm_b32 v187, v95, v91, s54
    v_perm_b32 v188, v71, v67, s55
    v_perm_b32 v189, v79, v75, s55
    v_perm_b32 v190, v87, v83, s55
    v_perm_b32 v191, v95, v91, s55
    s_branch L_bloop
L_gather0:
    s_mov_b32 s53, 262144
L_gretry:
    s_mov_b32 s7, s58
    buffer_load_dwordx4 v[128:131], v192, s[48:51], s7 offen sc1
    s_add_u32 s7, s7, 8192
    buffer_load_dwordx4 v[132:135], v192, s[48:51], s7 offen sc1
    s_add_u32 s7, s7, 8192
    buffer_load_dwordx4 v[136:139], v192, s[48:51], s7 offen sc1
    s_add_u32 s7, s7, 8192
    buffer_load_dwordx4 v[140:143], v192, s[48:51], s7 offen sc1
    s_add_u32 s7, s7, 8192
    buffer_load_dwordx4 v[144:147], v192, s[48:51], s7 offen sc1
    s_add_u32 s7, s7, 8192
    buffer_load_dwordx4 v[148:151], v192, s[48:51], s7 offen sc1
    s_add_u32 s7, s7, 8192
    buffer_load_dwordx4 v[152:155], v192, s[48:51], s7 offen sc1
    s_waitcnt vmcnt(0)
    v_max3_u32 v20, v128, v132, v136
    v_max3_u32 v21, v140, v144, v148
    v_max3_u32 v20, v20, v21, v152
    v_cmp_eq_u32 vcc, -1, v20
    s_cbranch_vccz L_gok0
    s_sub_u32 s53, s53, 1
    s_cbranch_scc1 L_gok0
    s_sleep 32
    s_branch L_gretry
L_gok0:
    v_pk_add_f32 v[128:129], v[128:129], v[144:145]
    v_pk_add_f32 v[130:131], v[130:131], v[146:147]
    v_pk_add_f32 v[132:133], v[132:133], v[148:149]
    v_pk_add_f32 v[134:135], v[134:135], v[150:151]
    v_pk_add_f32 v[136:137], v[136:137], v[152:153]
    v_pk_add_f32 v[138:139], v[138:139], v[154:155]
    v_pk_add_f32 v[128:129], v[128:129], v[136:137]
    v_pk_add_f32 v[130:131], v[130:131], v[138:139]
    v_pk_add_f32 v[132:133], v[132:133], v[140:141]
    v_pk_add_f32 v[134:135], v[134:135], v[142:143]
    s_branch L_gok
L_gather1:
    s_mov_b32 s53, 262144
    s_add_u32 s7, s77, 8192
L_gretry1:
    buffer_load_dwordx4 v[128:131], v192, s[48:51], s77 offen sc1
    buffer_load_dwordx4 v[132:135], v192, s[48:51], s7 offen sc1
    s_waitcnt vmcnt(0)
    v_max_u32 v20, v128, v132
    v_cmp_eq_u32 vcc, -1, v20
    s_cbranch_vccz L_gok
    s_sub_u32 s53, s53, 1
    s_cbranch_scc1 L_gok
    s_cmp_eq_u32 s56, 3
    s_cbranch_scc1 L_gretry1
    s_sleep 32
    s_branch L_gretry1
L_gok:
    v_pk_add_f32 v[128:129], v[128:129], v[132:133]
    v_pk_add_f32 v[130:131], v[130:131], v[134:135]
L_gsum:
    s_nop 1
    v_permlane32_swap_b32 v128, v130
    v_permlane32_swap_b32 v129, v131
    s_nop 0
    v_add_f32 v128, v128, v130
    v_add_f32 v129, v129, v131
    s_nop 1
    v_permlane16_swap_b32 v128, v129
    s_nop 0
    v_add_f32 v128, v128, v129
    s_nop 1
    v_add_f32_dpp v128, v128, v128 row_ror:4 row_mask:0xf bank_mask:0xf
    s_nop 1
    v_add_f32_dpp v128, v128, v128 row_ror:8 row_mask:0xf bank_mask:0xf
    v_cvt_pk_bf16_f32 v128, v128, v128
    v_and_b32 v128, 0xffff0000, v128
    s_cmp_eq_u32 s63, 0
    s_cbranch_scc1 L_bbranch
    v_mul_f32 v128, s61, v128
    v_cvt_pk_bf16_f32 v128, v128, v128
    v_and_b32 v128, 0xffff0000, v128
    v_add_f32 v128, v128, v193
    v_cvt_pk_bf16_f32 v128, v128, v128
    s_mov_b32 exec_lo, 0x000f000f
    s_mov_b32 exec_hi, 0x000f000f
    global_store_short v198, v128, s[38:39]
    s_mov_b64 exec, -1
    s_branch L_bnext
L_bbranch:
    v_mul_f32 v128, s60, v128
    v_cvt_pk_bf16_f32 v128, v128, v128
    v_and_b32 v128, 0xffff0000, v128
    v_add_f32 v128, v194, v128
    v_cvt_pk_bf16_f32 v128, v128, v128
    v_and_b32 v128, 0xffff0000, v128
    v_mul_f32 v128, s62, v128
    v_cvt_pk_bf16_f32 v193, v128, v128
    v_and_b32 v193, 0xffff0000, v193
    s_mov_b32 s63, 1
    s_branch L_chk1
L_bloop:
    s_waitcnt vmcnt(0)
    v_mov_b32 v204, -1
    v_mov_b32 v205, -1
    v_mov_b32 v206, -1
    v_mov_b32 v207, -1
    v_mov_b32 v208, -1
    v_mov_b32 v209, -1
    v_mov_b32 v20, 18444
    s_mov_b32 s53, 2097152
Llw_19:
    ds_read_b32 v21, v20
    s_waitcnt lgkmcnt(0)
    v_readfirstlane_b32 s8, v21
    s_cmp_ge_u32 s8, s67
    s_cbranch_scc1 Llwd_20
    s_sub_u32 s53, s53, 1
    s_cbranch_scc1 Llwd_20
    s_sleep 1
    s_branch Llw_19
Llwd_20:
    v_mov_b32 v20, s65
    ds_read_b128 v[144:147], v20
    ds_read_b128 v[148:151], v20 offset:16
    ds_read_b128 v[128:131], v200 offset:0
    ds_read_b128 v[132:135], v200 offset:512
    ds_read_b128 v[136:139], v200 offset:1024
    ds_read_b128 v[140:143], v200 offset:1536
    s_mov_b32 s7, 0xff7fffff
    v_cmp_eq_u32 vcc, 8, v0
    s_waitcnt lgkmcnt(4)
    v_max3_f32 v22, v144, v146, v148
    v_max3_f32 v22, v22, v150, s7
    v_sub_f32 v144, v144, v22
    v_sub_f32 v146, v146, v22
    v_sub_f32 v148, v148, v22
    v_sub_f32 v150, v150, v22
    v_exp_f32 v144, v144
    v_exp_f32 v146, v146
    v_exp_f32 v148, v148
    v_exp_f32 v150, v150
    v_mul_f32 v23, v144, v145
    v_fmac_f32 v23, v146, v147
    v_fmac_f32 v23, v148, v149
    v_fmac_f32 v23, v150, v151
    s_waitcnt lgkmcnt(0)
    v_mul_f32 v24, v144, v128
    v_mul_f32 v25, v144, v129
    v_mul_f32 v26, v144, v130
    v_mul_f32 v27, v144, v131
    v_fmac_f32 v24, v146, v132
    v_fmac_f32 v25, v146, v133
    v_fmac_f32 v26, v146, v134
    v_fmac_f32 v27, v146, v135
    v_fmac_f32 v24, v148, v136
    v_fmac_f32 v25, v148, v137
    v_fmac_f32 v26, v148, v138
    v_fmac_f32 v27, v148, v139
    v_fmac_f32 v24, v150, v140
    v_fmac_f32 v25, v150, v141
    v_fmac_f32 v26, v150, v142
    v_fmac_f32 v27, v150, v143
    v_cndmask_b32 v24, v24, v22, vcc
    v_cndmask_b32 v25, v25, v23, vcc
    v_min_u32 v26, 0xfffffffe, v26
    v_min_u32 v27, 0xfffffffe, v27
    v_min_u32 v24, 0xfffffffe, v24
    v_min_u32 v25, 0xfffffffe, v25
    s_mov_b64 exec, 0x1ff
    buffer_store_dwordx4 v[24:27], v199, s[48:51], s64 offen sc1
    s_mov_b64 exec, -1
    s_mov_b32 s53, 262144
    s_cmp_eq_u32 s56, 3
    s_cbranch_scc1 L_aretry
L_mretry:
    s_sleep 32
    buffer_load_dword v144, v196, s[48:51], s64 offen offset:1024 sc1
    s_waitcnt vmcnt(0)
    v_cmp_eq_u32 vcc, -1, v144
    s_cbranch_vccz L_aretry
    s_sub_u32 s53, s53, 1
    s_cbranch_scc0 L_mretry
L_aretry:
    s_mov_b64 vcc, -1
L_apoll:
    s_mov_b64 exec, vcc
    buffer_load_dwordx2 v[208:209], v196, s[48:51], s64 offen offset:1024 sc1
    buffer_load_dwordx4 v[204:207], v195, s[48:51], s64 offen sc1
    s_mov_b64 exec, -1
    s_sleep 1
    v_max3_u32 v20, v204, v205, v206
    v_max3_u32 v21, v207, v208, v209
    v_max_u32 v20, v20, v21
    v_cmp_eq_u32 vcc, -1, v20
    s_cbranch_vccz L_aok
    s_sleep 1
    v_max3_u32 v20, v204, v205, v206
    v_max3_u32 v21, v207, v208, v209
    v_max_u32 v20, v20, v21
    v_cmp_eq_u32 vcc, -1, v20
    s_cbranch_vccz L_aok
    s_sleep 1
    v_max3_u32 v20, v204, v205, v206
    v_max3_u32 v21, v207, v208, v209
    v_max_u32 v20, v20, v21
    v_cmp_eq_u32 vcc, -1, v20
    s_cbranch_vccz L_aok
    s_sleep 1
    v_max3_u32 v20, v204, v205, v206
    v_max3_u32 v21, v207, v208, v209
    v_max_u32 v20, v20, v21
    v_cmp_eq_u32 vcc, -1, v20
    s_cbranch_vccz L_aok
    s_sleep 1
    v_max3_u32 v20, v204, v205, v206
    v_max3_u32 v21, v207, v208, v209
    v_max_u32 v20, v20, v21
    v_cmp_eq_u32 vcc, -1, v20
    s_cbranch_vccz L_aok
    s_waitcnt vmcnt(10)
    s_sub_u32 s53, s53, 1
    s_cbranch_scc0 L_apoll
L_aok:
    v_max_f32_dpp v22, v208, v208 row_ror:2 row_mask:0xf bank_mask:0xf
    s_add_u32 s64, s64, 8192
    s_add_u32 s65, s65, 32
    v_max_f32_dpp v22, v22, v22 row_ror:4 row_mask:0xf bank_mask:0xf
    s_nop 1
    v_max_f32_dpp v22, v22, v22 row_ror:8 row_mask:0xf bank_mask:0xf
    v_sub_f32 v29, v208, v22
    v_exp_f32 v29, v29
    v_add_u32 v200, 2048, v200
    v_mul_f32 v28, v29, v209
    v_mul_f32 v24, v29, v204
    v_mul_f32 v25, v29, v205
    v_mul_f32 v26, v29, v206
    v_mul_f32 v27, v29, v207
    v_add_f32_dpp v28, v28, v28 row_ror:2 row_mask:0xf bank_mask:0xf
    v_add_f32_dpp v24, v24, v24 row_ror:2 row_mask:0xf bank_mask:0xf
    v_add_f32_dpp v25, v25, v25 row_ror:2 row_mask:0xf bank_mask:0xf
    v_add_f32_dpp v26, v26, v26 row_ror:2 row_mask:0xf bank_mask:0xf
    v_add_f32_dpp v27, v27, v27 row_ror:2 row_mask:0xf bank_mask:0xf
    v_add_f32_dpp v28, v28, v28 row_ror:4 row_mask:0xf bank_mask:0xf
    v_add_f32_dpp v24, v24, v24 row_ror:4 row_mask:0xf bank_mask:0xf
    v_add_f32_dpp v25, v25, v25 row_ror:4 row_mask:0xf bank_mask:0xf
    v_add_f32_dpp v26, v26, v26 row_ror:4 row_mask:0xf bank_mask:0xf
    v_add_f32_dpp v27, v27, v27 row_ror:4 row_mask:0xf bank_mask:0xf
    v_add_f32_dpp v28, v28, v28 row_ror:8 row_mask:0xf bank_mask:0xf
    v_add_f32_dpp v24, v24, v24 row_ror:8 row_mask:0xf bank_mask:0xf
    v_add_f32_dpp v25, v25, v25 row_ror:8 row_mask:0xf bank_mask:0xf
    v_add_f32_dpp v26, v26, v26 row_ror:8 row_mask:0xf bank_mask:0xf
    v_add_f32_dpp v27, v27, v27 row_ror:8 row_mask:0xf bank_mask:0xf
    v_rcp_f32 v28, v28
    s_nop 0
    v_mul_f32 v24, v24, v28
    v_mul_f32 v25, v25, v28
    v_mul_f32 v26, v26, v28
    v_mul_f32 v27, v27, v28
    v_cvt_pk_bf16_f32 v24, v24, v25
    v_cvt_pk_bf16_f32 v25, v26, v27
    s_nop 1
    v_mov_b32_dpp v4, v24 quad_perm:[0,0,2,2] row_mask:0xf bank_mask:0xf
    v_mov_b32_dpp v5, v25 quad_perm:[0,0,2,2] row_mask:0xf bank_mask:0xf
    v_mov_b32_dpp v6, v24 quad_perm:[1,1,3,3] row_mask:0xf bank_mask:0xf
    v_mov_b32_dpp v7, v25 quad_perm:[1,1,3,3] row_mask:0xf bank_mask:0xf
    s_nop 1
    v_mfma_f32_16x16x32_bf16 v[128:131], v[4:7], v[160:163], 0
    v_mfma_f32_16x16x32_bf16 v[132:135], v[4:7], v[164:167], 0
    v_mfma_f32_16x16x32_bf16 v[136:139], v[4:7], v[168:171], 0
    v_mfma_f32_16x16x32_bf16 v[140:143], v[4:7], v[172:175], 0
    v_mfma_f32_16x16x32_bf16 v[144:147], v[4:7], v[176:179], 0
    v_mfma_f32_16x16x32_bf16 v[148:151], v[4:7], v[180:183], 0
    v_mfma_f32_16x16x32_bf16 v[152:155], v[4:7], v[184:187], 0
    v_mfma_f32_16x16x32_bf16 v[156:159], v[4:7], v[188:191], 0
    s_nop 1
    v_min_u32 v12, 0xfffffffe, v128
    v_min_u32 v13, 0xfffffffe, v132
    v_min_u32 v14, 0xfffffffe, v136
    v_min_u32 v15, 0xfffffffe, v140
    v_min_u32 v16, 0xfffffffe, v144
    v_min_u32 v17, 0xfffffffe, v148
    v_min_u32 v18, 0xfffffffe, v152
    s_nop 0
    v_min_u32 v19, 0xfffffffe, v156
    s_mov_b64 exec, 0xffff
    ds_write_b128 v201, v[12:15]
    ds_write_b128 v201, v[16:19] offset:16
    s_mov_b64 exec, -1
    v_mov_b32 v20, 18440
    v_mov_b32 v21, 1
    s_mov_b64 exec, 1
    ds_add_u32 v20, v21
    s_mov_b64 exec, -1
    v_mov_b32 v20, 18440
    s_mov_b32 s53, 2097152
Llw_21:
    ds_read_b32 v21, v20
    s_waitcnt lgkmcnt(0)
    v_readfirstlane_b32 s8, v21
    s_cmp_ge_u32 s8, s67
    s_cbranch_scc1 Llwd_22
    s_sub_u32 s53, s53, 1
    s_cbranch_scc1 Llwd_22
    s_branch Llw_21
Llwd_22:
    ds_read_b128 v[128:131], v202 offset:0
    ds_read_b128 v[132:135], v202 offset:512
    ds_read_b128 v[136:139], v202 offset:1024
    ds_read_b128 v[140:143], v202 offset:1536
    v_xor_b32 v201, 2048, v201
    v_xor_b32 v202, 2048, v202
    s_add_u32 s67, s67, 4
    s_waitcnt lgkmcnt(0)
    v_pk_add_f32 v[128:129], v[128:129], v[132:133]
    v_pk_add_f32 v[136:137], v[136:137], v[140:141]
    v_pk_add_f32 v[130:131], v[130:131], v[134:135]
    v_pk_add_f32 v[138:139], v[138:139], v[142:143]
    v_pk_add_f32 v[128:129], v[128:129], v[136:137]
    v_pk_add_f32 v[130:131], v[130:131], v[138:139]
    v_min_u32 v128, 0xfffffffe, v128
    v_min_u32 v129, 0xfffffffe, v129
    v_min_u32 v130, 0xfffffffe, v130
    v_min_u32 v131, 0xfffffffe, v131
    s_mov_b64 exec, 0xff
    buffer_store_dwordx4 v[128:131], v197, s[48:51], s66 offen sc1
    s_mov_b64 exec, -1
    s_add_u32 s66, s66, 0x20000
    s_cmp_lg_u32 s52, 0
    s_cbranch_scc1 L_bnext
    s_cmp_eq_u32 s56, 1
    s_cbranch_scc1 L_gather0
L_chk1:
    s_cmp_eq_u32 s56, s57
    s_cbranch_scc1 L_gather1
L_bnext:
    s_add_u32 s56, s56, 1
    s_cmp_lt_u32 s56, 4
    s_cbranch_scc1 L_bloop
    s_waitcnt vmcnt(0)
    s_endpgm
L_stream:
    v_and_b32 v3, 15, v0
    v_lshrrev_b32 v28, 4, v0
    v_lshrrev_b32 v29, 2, v3
    v_and_b32 v1, 1, v29
    v_lshlrev_b32 v1, 8, v1
    v_bfe_u32 v30, v29, 1, 1
    v_lshl_add_u32 v1, v30, 9, v1
    v_and_b32 v2, 1, v28
    v_lshlrev_b32 v2, 8, v2
    v_bfe_u32 v30, v28, 1, 1
    v_lshl_add_u32 v2, v30, 9, v2
    v_lshl_add_u32 v1, v28, 6, v1
    v_and_b32 v29, 3, v0
    v_lshl_add_u32 v1, v29, 4, v1
    v_lshl_add_u32 v2, v3, 4, v2
    s_lshl_b32 s8, s5, 2
    s_add_u32 s8, s8, s3
    s_lshl_b32 s7, s4, 21
    s_mul_i32 s62, s4, 32
    s_mov_b32 s71, s8
    s_add_u32 s68, s71, s62
    s_bfe_u32 s56, s68, 0x40000
    s_lshl_b32 s56, s56, 12
    s_bfe_u32 s69, s68, 0x20004
    s_lshl_b32 s69, s69, 10
    s_or_b32 s56, s56, s69
    s_bfe_u32 s69, s68, 0x30006
    s_lshl_b32 s69, s69, 18
    s_or_b32 s56, s56, s69
    s_add_u32 s68, s56, 65536
    s_add_u32 s69, s56, 131072
    s_add_u32 s70, s56, 196608
    s_mul_i32 s9, s4, 4352
    s_add_u32 s9, s9, 8454144
    s_and_b32 s76, s3, 3
    s_mul_i32 s76, s76, 1088
    s_add_u32 s9, s9, s76
    s_mov_b32 s46, 0xc200000
    s_mov_b32 s47, 0x20000
    s_mov_b32 s50, 0xc200000
    s_mov_b32 s51, 0x20000
    s_mov_b32 s78, 0
    s_mul_i32 s84, s5, 8
    s_add_u32 s84, s84, s3
    s_add_u32 s84, s84, 160
    s_mov_b32 s79, 0x20000
    s_waitcnt lgkmcnt(0)
    s_add_u32 s44, s18, s7
    s_addc_u32 s45, s19, 0
    s_add_u32 s48, s20, s7
    s_addc_u32 s49, s21, 0
    s_add_u32 s76, s42, s9
    s_addc_u32 s77, s43, 0
    s_barrier
L_nocl:
    buffer_load_dwordx4 v[56:59], v1, s[44:47], s56 offen offset:0 nt
    buffer_load_dwordx4 v[60:63], v1, s[44:47], s68 offen offset:0 nt
    buffer_load_dwordx4 v[64:67], v1, s[44:47], s69 offen offset:0 nt
    buffer_load_dwordx4 v[68:71], v1, s[44:47], s70 offen offset:0 nt
    buffer_load_dwordx4 v[72:75], v2, s[48:51], s56 offen offset:0 nt
    buffer_load_dwordx4 v[76:79], v2, s[48:51], s68 offen offset:0 nt
    buffer_load_dwordx4 v[80:83], v2, s[48:51], s69 offen offset:0 nt
    buffer_load_dwordx4 v[84:87], v2, s[48:51], s70 offen offset:0 nt
    v_and_b32 v29, 1, v0
    v_mov_b32 v30, 0xffff
    v_mov_b32 v52, 0xffff0000
    v_cmp_eq_u32 vcc, 1, v29
    v_bfe_u32 v53, v0, 1, 2
    s_nop 1
    v_cndmask_b32 v30, v30, v52, vcc
    v_cmp_eq_u32 vcc, 0, v53
    s_nop 1
    v_cndmask_b32 v4, 0, v30, vcc
    v_cmp_eq_u32 vcc, 1, v53
    s_nop 1
    v_cndmask_b32 v5, 0, v30, vcc
    v_cmp_eq_u32 vcc, 2, v53
    s_nop 1
    v_cndmask_b32 v6, 0, v30, vcc
    v_cmp_eq_u32 vcc, 3, v53
    s_nop 1
    v_cndmask_b32 v7, 0, v30, vcc
    s_mov_b32 s52, 0x3db504f3
    s_mov_b32 s53, 0x3fb8aa3b
    s_mov_b32 s57, 0
    s_lshl_b32 s60, s3, 9
    s_add_u32 s60, s60, 20480
    s_lshl_b32 s61, s3, 3
    s_add_u32 s61, s61, 18688
    s_add_u32 s7, s8, 160
    v_mov_b32 v248, s7
    s_mov_b32 s64, 0
    s_add_u32 s7, s8, 192
    v_mov_b32 v249, s7
    s_mov_b32 s65, 0
    s_add_u32 s71, s71, 32
    s_add_u32 s68, s71, s62
    s_bfe_u32 s56, s68, 0x40000
    s_lshl_b32 s56, s56, 12
    s_bfe_u32 s69, s68, 0x20004
    s_lshl_b32 s69, s69, 10
    s_or_b32 s56, s56, s69
    s_bfe_u32 s69, s68, 0x30006
    s_lshl_b32 s69, s69, 18
    s_or_b32 s56, s56, s69
    s_add_u32 s68, s56, 65536
    s_add_u32 s69, s56, 131072
    s_add_u32 s70, s56, 196608
    s_waitcnt vmcnt(4)
    buffer_load_dwordx4 v[88:91], v1, s[44:47], s56 offen offset:0 nt
    buffer_load_dwordx4 v[92:95], v1, s[44:47], s68 offen offset:0 nt
    buffer_load_dwordx4 v[96:99], v1, s[44:47], s69 offen offset:0 nt
    buffer_load_dwordx4 v[100:103], v1, s[44:47], s70 offen offset:0 nt
    s_waitcnt vmcnt(4)
    buffer_load_dwordx4 v[104:107], v2, s[48:51], s56 offen offset:0 nt
    buffer_load_dwordx4 v[108:111], v2, s[48:51], s68 offen offset:0 nt
    buffer_load_dwordx4 v[112:115], v2, s[48:51], s69 offen offset:0 nt
    buffer_load_dwordx4 v[116:119], v2, s[48:51], s70 offen offset:0 nt
    s_add_u32 s71, s71, 32
    s_add_u32 s68, s71, s62
    s_bfe_u32 s56, s68, 0x40000
    s_lshl_b32 s56, s56, 12
    s_bfe_u32 s69, s68, 0x20004
    s_lshl_b32 s69, s69, 10
    s_or_b32 s56, s56, s69
    s_bfe_u32 s69, s68, 0x30006
    s_lshl_b32 s69, s69, 18
    s_or_b32 s56, s56, s69
    s_add_u32 s68, s56, 65536
    s_add_u32 s69, s56, 131072
    s_add_u32 s70, s56, 196608
    s_waitcnt vmcnt(4)
    buffer_load_dwordx4 v[120:123], v1, s[44:47], s56 offen offset:0 nt
    buffer_load_dwordx4 v[124:127], v1, s[44:47], s68 offen offset:0 nt
    buffer_load_dwordx4 v[128:131], v1, s[44:47], s69 offen offset:0 nt
    buffer_load_dwordx4 v[132:135], v1, s[44:47], s70 offen offset:0 nt
    s_waitcnt vmcnt(4)
    buffer_load_dwordx4 v[136:139], v2, s[48:51], s56 offen offset:0 nt
    buffer_load_dwordx4 v[140:143], v2, s[48:51], s68 offen offset:0 nt
    buffer_load_dwordx4 v[144:147], v2, s[48:51], s69 offen offset:0 nt
    buffer_load_dwordx4 v[148:151], v2, s[48:51], s70 offen offset:0 nt
    s_add_u32 s71, s71, 32
    s_add_u32 s68, s71, s62
    s_bfe_u32 s56, s68, 0x40000
    s_lshl_b32 s56, s56, 12
    s_bfe_u32 s69, s68, 0x20004
    s_lshl_b32 s69, s69, 10
    s_or_b32 s56, s56, s69
    s_bfe_u32 s69, s68, 0x30006
    s_lshl_b32 s69, s69, 18
    s_or_b32 s56, s56, s69
    s_add_u32 s68, s56, 65536
    s_add_u32 s69, s56, 131072
    s_add_u32 s70, s56, 196608
    s_waitcnt vmcnt(4)
    buffer_load_dwordx4 v[152:155], v1, s[44:47], s56 offen offset:0 nt
    buffer_load_dwordx4 v[156:159], v1, s[44:47], s68 offen offset:0 nt
    buffer_load_dwordx4 v[160:163], v1, s[44:47], s69 offen offset:0 nt
    buffer_load_dwordx4 v[164:167], v1, s[44:47], s70 offen offset:0 nt
    s_waitcnt vmcnt(4)
    buffer_load_dwordx4 v[168:171], v2, s[48:51], s56 offen offset:0 nt
    buffer_load_dwordx4 v[172:175], v2, s[48:51], s68 offen offset:0 nt
    buffer_load_dwordx4 v[176:179], v2, s[48:51], s69 offen offset:0 nt
    buffer_load_dwordx4 v[180:183], v2, s[48:51], s70 offen offset:0 nt
    s_add_u32 s71, s71, 32
    s_add_u32 s68, s71, s62
    s_bfe_u32 s56, s68, 0x40000
    s_lshl_b32 s56, s56, 12
    s_bfe_u32 s69, s68, 0x20004
    s_lshl_b32 s69, s69, 10
    s_or_b32 s56, s56, s69
    s_bfe_u32 s69, s68, 0x30006
    s_lshl_b32 s69, s69, 18
    s_or_b32 s56, s56, s69
    s_add_u32 s68, s56, 65536
    s_add_u32 s69, s56, 131072
    s_add_u32 s70, s56, 196608
    s_waitcnt vmcnt(4)
    buffer_load_dwordx4 v[184:187], v1, s[44:47], s56 offen offset:0 nt
    buffer_load_dwordx4 v[188:191], v1, s[44:47], s68 offen offset:0 nt
    buffer_load_dwordx4 v[192:195], v1, s[44:47], s69 offen offset:0 nt
    buffer_load_dwordx4 v[196:199], v1, s[44:47], s70 offen offset:0 nt
    s_waitcnt vmcnt(4)
    buffer_load_dwordx4 v[200:203], v2, s[48:51], s56 offen offset:0 nt
    buffer_load_dwordx4 v[204:207], v2, s[48:51], s68 offen offset:0 nt
    buffer_load_dwordx4 v[208:211], v2, s[48:51], s69 offen offset:0 nt
    buffer_load_dwordx4 v[212:215], v2, s[48:51], s70 offen offset:0 nt
    v_lshrrev_b32 v28, 4, v0
    v_mul_u32_u24 v8, 57344, v28
    v_lshl_add_u32 v8, v3, 4, v8
    v_mul_u32_u24 v9, 16384, v28
    v_lshl_add_u32 v9, v3, 4, v9
    s_mov_b32 s83, 0x20000
    s_lshl_b32 s10, s3, 13
    s_add_u32 s10, s10, 28672
    s_lshr_b32 s9, s5, 1
    s_lshl_b32 s9, s9, 16
    s_and_b32 s8, s5, 1
    s_lshl_b32 s8, s8, 10
    s_add_u32 s9, s9, s8
    s_lshl_b32 s8, s3, 8
    s_add_u32 s9, s9, s8
    s_cmp_ge_u32 s6, 28
    s_cbranch_scc1 L_nowm
    s_lshl_b32 s7, s5, 2
    s_add_u32 s7, s7, s3
    s_mul_i32 s7, s7, 229376
    s_lshl_b32 s8, s6, 8
    s_add_u32 s7, s7, s8
    s_add_u32 s80, s30, s7
    s_addc_u32 s81, s31, 0
    s_mov_b32 s82, 222464
    s_add_u32 m0, s10, 0
    s_waitcnt vmcnt(4)
    s_mov_b32 s8, 0
    buffer_load_dwordx4 v8, s[80:83], s8 offen nt lds
    s_add_u32 m0, m0, 1024
    s_mov_b32 s8, 7168
    buffer_load_dwordx4 v8, s[80:83], s8 offen nt lds
    s_add_u32 m0, m0, 1024
    s_mov_b32 s8, 14336
    buffer_load_dwordx4 v8, s[80:83], s8 offen nt lds
    s_add_u32 m0, m0, 1024
    s_mov_b32 s8, 21504
    buffer_load_dwordx4 v8, s[80:83], s8 offen nt lds
    s_waitcnt vmcnt(4)
    s_add_u32 m0, m0, 1024
    s_mov_b32 s8, 28672
    buffer_load_dwordx4 v8, s[80:83], s8 offen nt lds
    s_add_u32 m0, m0, 1024
    s_mov_b32 s8, 35840
    buffer_load_dwordx4 v8, s[80:83], s8 offen nt lds
    s_add_u32 m0, m0, 1024
    s_mov_b32 s8, 43008
    buffer_load_dwordx4 v8, s[80:83], s8 offen nt lds
    s_add_u32 m0, m0, 1024
    s_mov_b32 s8, 50176
    buffer_load_dwordx4 v8, s[80:83], s8 offen nt lds
    s_add_u32 s80, s32, s7
    s_addc_u32 s81, s33, 0
    s_mov_b32 s82, 222464
    s_add_u32 m0, s10, 32768
    s_waitcnt vmcnt(4)
    s_mov_b32 s8, 0
    buffer_load_dwordx4 v8, s[80:83], s8 offen nt lds
    s_add_u32 m0, m0, 1024
    s_mov_b32 s8, 7168
    buffer_load_dwordx4 v8, s[80:83], s8 offen nt lds
    s_add_u32 m0, m0, 1024
    s_mov_b32 s8, 14336
    buffer_load_dwordx4 v8, s[80:83], s8 offen nt lds
    s_add_u32 m0, m0, 1024
    s_mov_b32 s8, 21504
    buffer_load_dwordx4 v8, s[80:83], s8 offen nt lds
    s_waitcnt vmcnt(4)
    s_add_u32 m0, m0, 1024
    s_mov_b32 s8, 28672
    buffer_load_dwordx4 v8, s[80:83], s8 offen nt lds
    s_add_u32 m0, m0, 1024
    s_mov_b32 s8, 35840
    buffer_load_dwordx4 v8, s[80:83], s8 offen nt lds
    s_add_u32 m0, m0, 1024
    s_mov_b32 s8, 43008
    buffer_load_dwordx4 v8, s[80:83], s8 offen nt lds
    s_add_u32 m0, m0, 1024
    s_mov_b32 s8, 50176
    buffer_load_dwordx4 v8, s[80:83], s8 offen nt lds
    s_lshl_b32 s7, s6, 18
    s_add_u32 s7, s7, s9
    s_add_u32 s80, s34, s7
    s_addc_u32 s81, s35, 0
    s_mov_b32 s82, 63744
    s_add_u32 m0, s10, 65536
    s_waitcnt vmcnt(4)
    s_mov_b32 s8, 0
    buffer_load_dwordx4 v9, s[80:83], s8 offen nt lds
    s_add_u32 m0, m0, 1024
    s_mov_b32 s8, 2048
    buffer_load_dwordx4 v9, s[80:83], s8 offen nt lds
    s_add_u32 m0, m0, 1024
    s_mov_b32 s8, 4096
    buffer_load_dwordx4 v9, s[80:83], s8 offen nt lds
    s_add_u32 m0, m0, 1024
    s_mov_b32 s8, 6144
    buffer_load_dwordx4 v9, s[80:83], s8 offen nt lds
    s_waitcnt vmcnt(4)
    s_add_u32 m0, m0, 1024
    s_mov_b32 s8, 8192
    buffer_load_dwordx4 v9, s[80:83], s8 offen nt lds
    s_add_u32 m0, m0, 1024
    s_mov_b32 s8, 10240
    buffer_load_dwordx4 v9, s[80:83], s8 offen nt lds
    s_add_u32 m0, m0, 1024
    s_mov_b32 s8, 12288
    buffer_load_dwordx4 v9, s[80:83], s8 offen nt lds
    s_add_u32 m0, m0, 1024
    s_mov_b32 s8, 14336
    buffer_load_dwordx4 v9, s[80:83], s8 offen nt lds
L_nowm:
    s_lshl_b32 s7, s4, 18
    s_lshl_b32 s8, s3, 16
    s_add_u32 s7, s7, s8
    s_lshl_b32 s8, s5, 8
    s_add_u32 s7, s7, s8
    s_add_u32 s80, s24, s7
    s_addc_u32 s81, s25, 0
    s_mov_b32 s82, 63744
    s_add_u32 m0, s10, 98304
    s_waitcnt vmcnt(4)
    s_mov_b32 s8, 0
    buffer_load_dwordx4 v9, s[80:83], s8 offen nt lds
    s_add_u32 m0, m0, 1024
    s_mov_b32 s8, 2048
    buffer_load_dwordx4 v9, s[80:83], s8 offen nt lds
    s_add_u32 m0, m0, 1024
    s_mov_b32 s8, 4096
    buffer_load_dwordx4 v9, s[80:83], s8 offen nt lds
    s_add_u32 m0, m0, 1024
    s_mov_b32 s8, 6144
    buffer_load_dwordx4 v9, s[80:83], s8 offen nt lds
    s_waitcnt vmcnt(4)
    s_add_u32 m0, m0, 1024
    s_mov_b32 s8, 8192
    buffer_load_dwordx4 v9, s[80:83], s8 offen nt lds
    s_add_u32 m0, m0, 1024
    s_mov_b32 s8, 10240
    buffer_load_dwordx4 v9, s[80:83], s8 offen nt lds
    s_add_u32 m0, m0, 1024
    s_mov_b32 s8, 12288
    buffer_load_dwordx4 v9, s[80:83], s8 offen nt lds
    s_add_u32 m0, m0, 1024
    s_mov_b32 s8, 14336
    buffer_load_dwordx4 v9, s[80:83], s8 offen nt lds
    s_waitcnt vmcnt(8)
    s_barrier
    s_mov_b32 s58, 2
    s_branch L_newq
L_back_2:
    s_waitcnt vmcnt(44)
    v_readfirstlane_b32 s64, v248
    v_mfma_f32_16x16x32_bf16 v[24:27], v[56:59], v[8:11], 0
    v_mfma_f32_16x16x32_bf16 v[24:27], v[60:63], v[12:15], v[24:27]
    v_mfma_f32_16x16x32_bf16 v[24:27], v[64:67], v[16:19], v[24:27]
    v_mfma_f32_16x16x32_bf16 v[24:27], v[68:71], v[20:23], v[24:27]
    v_mov_b32 v248, 8
    s_mov_b64 exec, 1
    buffer_atomic_add v248, off, s[76:79], 0 sc0
    s_mov_b64 exec, -1
    s_lshr_b32 s7, s64, 9
    s_lshl_b32 s7, s7, 26
    s_add_u32 s68, s64, s62
    s_bfe_u32 s69, s68, 0x40000
    s_lshl_b32 s69, s69, 12
    s_or_b32 s56, s7, s69
    s_bfe_u32 s69, s68, 0x20004
    s_lshl_b32 s69, s69, 10
    s_or_b32 s56, s56, s69
    s_bfe_u32 s69, s68, 0x30006
    s_lshl_b32 s69, s69, 18
    s_or_b32 s56, s56, s69
    s_add_u32 s68, s56, 65536
    s_add_u32 s69, s56, 131072
    s_add_u32 s70, s56, 196608
    buffer_load_dwordx4 v[56:59], v1, s[44:47], s56 offen offset:0 nt
    buffer_load_dwordx4 v[60:63], v1, s[44:47], s68 offen offset:0 nt
    buffer_load_dwordx4 v[64:67], v1, s[44:47], s69 offen offset:0 nt
    buffer_load_dwordx4 v[68:71], v1, s[44:47], s70 offen offset:0 nt
    v_mov_b32_dpp v28, v24 quad_perm:[0,0,0,0] row_mask:0xf bank_mask:0xf
    v_mov_b32_dpp v29, v26 quad_perm:[2,2,2,2] row_mask:0xf bank_mask:0xf
    s_nop 0
    v_add_f32_dpp v28, v25, v28 quad_perm:[1,1,1,1] row_mask:0xf bank_mask:0xf
    v_add_f32_dpp v29, v27, v29 quad_perm:[3,3,3,3] row_mask:0xf bank_mask:0xf
    v_add_f32 v28, v28, v29
    v_cvt_pk_bf16_f32 v28, v28, v28
    v_and_b32 v28, 0xffff0000, v28
    v_mul_f32 v28, s52, v28
    v_cvt_pk_bf16_f32 v28, v28, v28
    v_and_b32 v28, 0xffff0000, v28
    v_mul_f32 v28, s53, v28
    v_cmp_lt_f32 vcc, s54, v28
    s_cbranch_vccnz Lrare_23
Lback_24:
    v_subrev_f32 v29, s54, v28
    v_exp_f32 v29, v29
    s_nop 0
    v_cvt_pk_bf16_f32 v30, v29, v29
    v_add_f32 v31, v31, v29
    s_nop 0
    v_and_b32_dpp v36, v30, v4 row_newbcast:0 row_mask:0xf bank_mask:0xf
    v_and_b32_dpp v37, v30, v5 row_newbcast:0 row_mask:0xf bank_mask:0xf
    v_and_b32_dpp v38, v30, v6 row_newbcast:0 row_mask:0xf bank_mask:0xf
    v_and_b32_dpp v39, v30, v7 row_newbcast:0 row_mask:0xf bank_mask:0xf
    v_and_b32_dpp v40, v30, v4 row_newbcast:4 row_mask:0xf bank_mask:0xf
    v_and_b32_dpp v41, v30, v5 row_newbcast:4 row_mask:0xf bank_mask:0xf
    v_and_b32_dpp v42, v30, v6 row_newbcast:4 row_mask:0xf bank_mask:0xf
    v_and_b32_dpp v43, v30, v7 row_newbcast:4 row_mask:0xf bank_mask:0xf
    v_and_b32_dpp v44, v30, v4 row_newbcast:8 row_mask:0xf bank_mask:0xf
    v_and_b32_dpp v45, v30, v5 row_newbcast:8 row_mask:0xf bank_mask:0xf
    v_and_b32_dpp v46, v30, v6 row_newbcast:8 row_mask:0xf bank_mask:0xf
    v_and_b32_dpp v47, v30, v7 row_newbcast:8 row_mask:0xf bank_mask:0xf
    v_and_b32_dpp v48, v30, v4 row_newbcast:12 row_mask:0xf bank_mask:0xf
    v_and_b32_dpp v49, v30, v5 row_newbcast:12 row_mask:0xf bank_mask:0xf
    v_and_b32_dpp v50, v30, v6 row_newbcast:12 row_mask:0xf bank_mask:0xf
    v_and_b32_dpp v51, v30, v7 row_newbcast:12 row_mask:0xf bank_mask:0xf
    s_waitcnt vmcnt(45)
    s_nop 0
    v_mfma_f32_16x16x32_bf16 v[32:35], v[36:39], v[72:75], v[32:35]
    v_mfma_f32_16x16x32_bf16 v[32:35], v[40:43], v[76:79], v[32:35]
    v_mfma_f32_16x16x32_bf16 v[32:35], v[44:47], v[80:83], v[32:35]
    v_mfma_f32_16x16x32_bf16 v[32:35], v[48:51], v[84:87], v[32:35]
    buffer_load_dwordx4 v[72:75], v2, s[48:51], s56 offen offset:0 nt
    buffer_load_dwordx4 v[76:79], v2, s[48:51], s68 offen offset:0 nt
    buffer_load_dwordx4 v[80:83], v2, s[48:51], s69 offen offset:0 nt
    buffer_load_dwordx4 v[84:87], v2, s[48:51], s70 offen offset:0 nt
    s_waitcnt vmcnt(45)
    v_readfirstlane_b32 s65, v249
    v_mfma_f32_16x16x32_bf16 v[24:27], v[88:91], v[8:11], 0
    v_mfma_f32_16x16x32_bf16 v[24:27], v[92:95], v[12:15], v[24:27]
    v_mfma_f32_16x16x32_bf16 v[24:27], v[96:99], v[16:19], v[24:27]
    v_mfma_f32_16x16x32_bf16 v[24:27], v[100:103], v[20:23], v[24:27]
    s_lshr_b32 s7, s65, 9
    s_lshl_b32 s7, s7, 26
    s_add_u32 s68, s65, s62
    s_bfe_u32 s69, s68, 0x40000
    s_lshl_b32 s69, s69, 12
    s_or_b32 s56, s7, s69
    s_bfe_u32 s69, s68, 0x20004
    s_lshl_b32 s69, s69, 10
    s_or_b32 s56, s56, s69
    s_bfe_u32 s69, s68, 0x30006
    s_lshl_b32 s69, s69, 18
    s_or_b32 s56, s56, s69
    s_add_u32 s68, s56, 65536
    s_add_u32 s69, s56, 131072
    s_add_u32 s70, s56, 196608
    buffer_load_dwordx4 v[88:91], v1, s[44:47], s56 offen offset:0 nt
    buffer_load_dwordx4 v[92:95], v1, s[44:47], s68 offen offset:0 nt
    buffer_load_dwordx4 v[96:99], v1, s[44:47], s69 offen offset:0 nt
    buffer_load_dwordx4 v[100:103], v1, s[44:47], s70 offen offset:0 nt
    v_mov_b32_dpp v28, v24 quad_perm:[0,0,0,0] row_mask:0xf bank_mask:0xf
    v_mov_b32_dpp v29, v26 quad_perm:[2,2,2,2] row_mask:0xf bank_mask:0xf
    s_nop 0
    v_add_f32_dpp v28, v25, v28 quad_perm:[1,1,1,1] row_mask:0xf bank_mask:0xf
    v_add_f32_dpp v29, v27, v29 quad_perm:[3,3,3,3] row_mask:0xf bank_mask:0xf
    v_add_f32 v28, v28, v29
    v_cvt_pk_bf16_f32 v28, v28, v28
    v_and_b32 v28, 0xffff0000, v28
    v_mul_f32 v28, s52, v28
    v_cvt_pk_bf16_f32 v28, v28, v28
    v_and_b32 v28, 0xffff0000, v28
    v_mul_f32 v28, s53, v28
    v_cmp_lt_f32 vcc, s54, v28
    s_cbranch_vccnz Lrare_25
Lback_26:
    v_subrev_f32 v29, s54, v28
    v_exp_f32 v29, v29
    s_nop 0
    v_cvt_pk_bf16_f32 v30, v29, v29
    v_add_f32 v31, v31, v29
    s_nop 0
    v_and_b32_dpp v36, v30, v4 row_newbcast:0 row_mask:0xf bank_mask:0xf
    v_and_b32_dpp v37, v30, v5 row_newbcast:0 row_mask:0xf bank_mask:0xf
    v_and_b32_dpp v38, v30, v6 row_newbcast:0 row_mask:0xf bank_mask:0xf
    v_and_b32_dpp v39, v30, v7 row_newbcast:0 row_mask:0xf bank_mask:0xf
    v_and_b32_dpp v40, v30, v4 row_newbcast:4 row_mask:0xf bank_mask:0xf
    v_and_b32_dpp v41, v30, v5 row_newbcast:4 row_mask:0xf bank_mask:0xf
    v_and_b32_dpp v42, v30, v6 row_newbcast:4 row_mask:0xf bank_mask:0xf
    v_and_b32_dpp v43, v30, v7 row_newbcast:4 row_mask:0xf bank_mask:0xf
    v_and_b32_dpp v44, v30, v4 row_newbcast:8 row_mask:0xf bank_mask:0xf
    v_and_b32_dpp v45, v30, v5 row_newbcast:8 row_mask:0xf bank_mask:0xf
    v_and_b32_dpp v46, v30, v6 row_newbcast:8 row_mask:0xf bank_mask:0xf
    v_and_b32_dpp v47, v30, v7 row_newbcast:8 row_mask:0xf bank_mask:0xf
    v_and_b32_dpp v48, v30, v4 row_newbcast:12 row_mask:0xf bank_mask:0xf
    v_and_b32_dpp v49, v30, v5 row_newbcast:12 row_mask:0xf bank_mask:0xf
    v_and_b32_dpp v50, v30, v6 row_newbcast:12 row_mask:0xf bank_mask:0xf
    v_and_b32_dpp v51, v30, v7 row_newbcast:12 row_mask:0xf bank_mask:0xf
    s_waitcnt vmcnt(45)
    s_nop 0
    v_mfma_f32_16x16x32_bf16 v[32:35], v[36:39], v[104:107], v[32:35]
    v_mfma_f32_16x16x32_bf16 v[32:35], v[40:43], v[108:111], v[32:35]
    v_mfma_f32_16x16x32_bf16 v[32:35], v[44:47], v[112:115], v[32:35]
    v_mfma_f32_16x16x32_bf16 v[32:35], v[48:51], v[116:119], v[32:35]
    buffer_load_dwordx4 v[104:107], v2, s[48:51], s56 offen offset:0 nt
    buffer_load_dwordx4 v[108:111], v2, s[48:51], s68 offen offset:0 nt
    buffer_load_dwordx4 v[112:115], v2, s[48:51], s69 offen offset:0 nt
    buffer_load_dwordx4 v[116:119], v2, s[48:51], s70 offen offset:0 nt
    s_waitcnt vmcnt(45)
    v_mfma_f32_16x16x32_bf16 v[24:27], v[120:123], v[8:11], 0
    v_mfma_f32_16x16x32_bf16 v[24:27], v[124:127], v[12:15], v[24:27]
    v_mfma_f32_16x16x32_bf16 v[24:27], v[128:131], v[16:19], v[24:27]
    v_mfma_f32_16x16x32_bf16 v[24:27], v[132:135], v[20:23], v[24:27]
    s_nop 7
    v_mov_b32_dpp v28, v24 quad_perm:[0,0,0,0] row_mask:0xf bank_mask:0xf
    v_mov_b32_dpp v29, v26 quad_perm:[2,2,2,2] row_mask:0xf bank_mask:0xf
    s_nop 0
    v_add_f32_dpp v28, v25, v28 quad_perm:[1,1,1,1] row_mask:0xf bank_mask:0xf
    v_add_f32_dpp v29, v27, v29 quad_perm:[3,3,3,3] row_mask:0xf bank_mask:0xf
    v_add_f32 v28, v28, v29
    v_cvt_pk_bf16_f32 v28, v28, v28
    v_and_b32 v28, 0xffff0000, v28
    v_mul_f32 v28, s52, v28
    v_cvt_pk_bf16_f32 v28, v28, v28
    v_and_b32 v28, 0xffff0000, v28
    v_mul_f32 v28, s53, v28
    v_cmp_lt_f32 vcc, s54, v28
    s_cbranch_vccnz Lrare_27
Lback_28:
    v_subrev_f32 v29, s54, v28
    v_exp_f32 v29, v29
    s_nop 0
    v_cvt_pk_bf16_f32 v30, v29, v29
    v_add_f32 v31, v31, v29
    s_nop 0
    v_and_b32_dpp v36, v30, v4 row_newbcast:0 row_mask:0xf bank_mask:0xf
    v_and_b32_dpp v37, v30, v5 row_newbcast:0 row_mask:0xf bank_mask:0xf
    v_and_b32_dpp v38, v30, v6 row_newbcast:0 row_mask:0xf bank_mask:0xf
    v_and_b32_dpp v39, v30, v7 row_newbcast:0 row_mask:0xf bank_mask:0xf
    v_and_b32_dpp v40, v30, v4 row_newbcast:4 row_mask:0xf bank_mask:0xf
    v_and_b32_dpp v41, v30, v5 row_newbcast:4 row_mask:0xf bank_mask:0xf
    v_and_b32_dpp v42, v30, v6 row_newbcast:4 row_mask:0xf bank_mask:0xf
    v_and_b32_dpp v43, v30, v7 row_newbcast:4 row_mask:0xf bank_mask:0xf
    v_and_b32_dpp v44, v30, v4 row_newbcast:8 row_mask:0xf bank_mask:0xf
    v_and_b32_dpp v45, v30, v5 row_newbcast:8 row_mask:0xf bank_mask:0xf
    v_and_b32_dpp v46, v30, v6 row_newbcast:8 row_mask:0xf bank_mask:0xf
    v_and_b32_dpp v47, v30, v7 row_newbcast:8 row_mask:0xf bank_mask:0xf
    v_and_b32_dpp v48, v30, v4 row_newbcast:12 row_mask:0xf bank_mask:0xf
    v_and_b32_dpp v49, v30, v5 row_newbcast:12 row_mask:0xf bank_mask:0xf
    v_and_b32_dpp v50, v30, v6 row_newbcast:12 row_mask:0xf bank_mask:0xf
    v_and_b32_dpp v51, v30, v7 row_newbcast:12 row_mask:0xf bank_mask:0xf
    s_waitcnt vmcnt(41)
    s_nop 0
    v_mfma_f32_16x16x32_bf16 v[32:35], v[36:39], v[136:139], v[32:35]
    v_mfma_f32_16x16x32_bf16 v[32:35], v[40:43], v[140:143], v[32:35]
    v_mfma_f32_16x16x32_bf16 v[32:35], v[44:47], v[144:147], v[32:35]
    v_mfma_f32_16x16x32_bf16 v[32:35], v[48:51], v[148:151], v[32:35]
    s_waitcnt vmcnt(37)
    v_mfma_f32_16x16x32_bf16 v[24:27], v[152:155], v[8:11], 0
    v_mfma_f32_16x16x32_bf16 v[24:27], v[156:159], v[12:15], v[24:27]
    v_mfma_f32_16x16x32_bf16 v[24:27], v[160:163], v[16:19], v[24:27]
    v_mfma_f32_16x16x32_bf16 v[24:27], v[164:167], v[20:23], v[24:27]
    s_nop 7
    v_mov_b32_dpp v28, v24 quad_perm:[0,0,0,0] row_mask:0xf bank_mask:0xf
    v_mov_b32_dpp v29, v26 quad_perm:[2,2,2,2] row_mask:0xf bank_mask:0xf
    s_nop 0
    v_add_f32_dpp v28, v25, v28 quad_perm:[1,1,1,1] row_mask:0xf bank_mask:0xf
    v_add_f32_dpp v29, v27, v29 quad_perm:[3,3,3,3] row_mask:0xf bank_mask:0xf
    v_add_f32 v28, v28, v29
    v_cvt_pk_bf16_f32 v28, v28, v28
    v_and_b32 v28, 0xffff0000, v28
    v_mul_f32 v28, s52, v28
    v_cvt_pk_bf16_f32 v28, v28, v28
    v_and_b32 v28, 0xffff0000, v28
    v_mul_f32 v28, s53, v28
    v_cmp_lt_f32 vcc, s54, v28
    s_cbranch_vccnz Lrare_29
Lback_30:
    v_subrev_f32 v29, s54, v28
    v_exp_f32 v29, v29
    s_nop 0
    v_cvt_pk_bf16_f32 v30, v29, v29
    v_add_f32 v31, v31, v29
    s_nop 0
    v_and_b32_dpp v36, v30, v4 row_newbcast:0 row_mask:0xf bank_mask:0xf
    v_and_b32_dpp v37, v30, v5 row_newbcast:0 row_mask:0xf bank_mask:0xf
    v_and_b32_dpp v38, v30, v6 row_newbcast:0 row_mask:0xf bank_mask:0xf
    v_and_b32_dpp v39, v30, v7 row_newbcast:0 row_mask:0xf bank_mask:0xf
    v_and_b32_dpp v40, v30, v4 row_newbcast:4 row_mask:0xf bank_mask:0xf
    v_and_b32_dpp v41, v30, v5 row_newbcast:4 row_mask:0xf bank_mask:0xf
    v_and_b32_dpp v42, v30, v6 row_newbcast:4 row_mask:0xf bank_mask:0xf
    v_and_b32_dpp v43, v30, v7 row_newbcast:4 row_mask:0xf bank_mask:0xf
    v_and_b32_dpp v44, v30, v4 row_newbcast:8 row_mask:0xf bank_mask:0xf
    v_and_b32_dpp v45, v30, v5 row_newbcast:8 row_mask:0xf bank_mask:0xf
    v_and_b32_dpp v46, v30, v6 row_newbcast:8 row_mask:0xf bank_mask:0xf
    v_and_b32_dpp v47, v30, v7 row_newbcast:8 row_mask:0xf bank_mask:0xf
    v_and_b32_dpp v48, v30, v4 row_newbcast:12 row_mask:0xf bank_mask:0xf
    v_and_b32_dpp v49, v30, v5 row_newbcast:12 row_mask:0xf bank_mask:0xf
    v_and_b32_dpp v50, v30, v6 row_newbcast:12 row_mask:0xf bank_mask:0xf
    v_and_b32_dpp v51, v30, v7 row_newbcast:12 row_mask:0xf bank_mask:0xf
    s_waitcnt vmcnt(33)
    s_nop 0
    v_mfma_f32_16x16x32_bf16 v[32:35], v[36:39], v[168:171], v[32:35]
    v_mfma_f32_16x16x32_bf16 v[32:35], v[40:43], v[172:175], v[32:35]
    v_mfma_f32_16x16x32_bf16 v[32:35], v[44:47], v[176:179], v[32:35]
    v_mfma_f32_16x16x32_bf16 v[32:35], v[48:51], v[180:183], v[32:35]
    s_waitcnt vmcnt(29)
    v_mfma_f32_16x16x32_bf16 v[24:27], v[184:187], v[8:11], 0
    v_mfma_f32_16x16x32_bf16 v[24:27], v[188:191], v[12:15], v[24:27]
    v_mfma_f32_16x16x32_bf16 v[24:27], v[192:195], v[16:19], v[24:27]
    v_mfma_f32_16x16x32_bf16 v[24:27], v[196:199], v[20:23], v[24:27]
    s_nop 7
    v_mov_b32_dpp v28, v24 quad_perm:[0,0,0,0] row_mask:0xf bank_mask:0xf
    v_mov_b32_dpp v29, v26 quad_perm:[2,2,2,2] row_mask:0xf bank_mask:0xf
    s_nop 0
    v_add_f32_dpp v28, v25, v28 quad_perm:[1,1,1,1] row_mask:0xf bank_mask:0xf
    v_add_f32_dpp v29, v27, v29 quad_perm:[3,3,3,3] row_mask:0xf bank_mask:0xf
    v_add_f32 v28, v28, v29
    v_cvt_pk_bf16_f32 v28, v28, v28
    v_and_b32 v28, 0xffff0000, v28
    v_mul_f32 v28, s52, v28
    v_cvt_pk_bf16_f32 v28, v28, v28
    v_and_b32 v28, 0xffff0000, v28
    v_mul_f32 v28, s53, v28
    v_cmp_lt_f32 vcc, s54, v28
    s_cbranch_vccnz Lrare_31
Lback_32:
    v_subrev_f32 v29, s54, v28
    v_exp_f32 v29, v29
    s_nop 0
    v_cvt_pk_bf16_f32 v30, v29, v29
    v_add_f32 v31, v31, v29
    s_nop 0
    v_and_b32_dpp v36, v30, v4 row_newbcast:0 row_mask:0xf bank_mask:0xf
    v_and_b32_dpp v37, v30, v5 row_newbcast:0 row_mask:0xf bank_mask:0xf
    v_and_b32_dpp v38, v30, v6 row_newbcast:0 row_mask:0xf bank_mask:0xf
    v_and_b32_dpp v39, v30, v7 row_newbcast:0 row_mask:0xf bank_mask:0xf
    v_and_b32_dpp v40, v30, v4 row_newbcast:4 row_mask:0xf bank_mask:0xf
    v_and_b32_dpp v41, v30, v5 row_newbcast:4 row_mask:0xf bank_mask:0xf
    v_and_b32_dpp v42, v30, v6 row_newbcast:4 row_mask:0xf bank_mask:0xf
    v_and_b32_dpp v43, v30, v7 row_newbcast:4 row_mask:0xf bank_mask:0xf
    v_and_b32_dpp v44, v30, v4 row_newbcast:8 row_mask:0xf bank_mask:0xf
    v_and_b32_dpp v45, v30, v5 row_newbcast:8 row_mask:0xf bank_mask:0xf
    v_and_b32_dpp v46, v30, v6 row_newbcast:8 row_mask:0xf bank_mask:0xf
    v_and_b32_dpp v47, v30, v7 row_newbcast:8 row_mask:0xf bank_mask:0xf
    v_and_b32_dpp v48, v30, v4 row_newbcast:12 row_mask:0xf bank_mask:0xf
    v_and_b32_dpp v49, v30, v5 row_newbcast:12 row_mask:0xf bank_mask:0xf
    v_and_b32_dpp v50, v30, v6 row_newbcast:12 row_mask:0xf bank_mask:0xf
    v_and_b32_dpp v51, v30, v7 row_newbcast:12 row_mask:0xf bank_mask:0xf
    s_waitcnt vmcnt(25)
    s_nop 0
    v_mfma_f32_16x16x32_bf16 v[32:35], v[36:39], v[200:203], v[32:35]
    v_mfma_f32_16x16x32_bf16 v[32:35], v[40:43], v[204:207], v[32:35]
    v_mfma_f32_16x16x32_bf16 v[32:35], v[44:47], v[208:211], v[32:35]
    v_mfma_f32_16x16x32_bf16 v[32:35], v[48:51], v[212:215], v[32:35]
    s_waitcnt vmcnt(17)
    .p2align 4
L_loop:
    s_lshr_b32 s7, s64, 9
    s_cmp_lg_u32 s7, s57
    s_cbranch_scc1 L_sw_0
L_back_0:
    s_waitcnt vmcnt(12)
    v_readfirstlane_b32 s85, v248
    s_add_u32 s84, s84, 64
    s_cmp_lt_u32 s84, 1120
    s_cselect_b32 s64, s84, s85
    s_cmp_lt_u32 s84, 1056
    s_cselect_b32 s78, 0, 4
    v_mfma_f32_16x16x32_bf16 v[24:27], v[56:59], v[8:11], 0
    v_mfma_f32_16x16x32_bf16 v[24:27], v[60:63], v[12:15], v[24:27]
    v_mfma_f32_16x16x32_bf16 v[24:27], v[64:67], v[16:19], v[24:27]
    v_mfma_f32_16x16x32_bf16 v[24:27], v[68:71], v[20:23], v[24:27]
    v_mov_b32 v248, 8
    s_mov_b64 exec, 1
    buffer_atomic_add v248, off, s[76:79], 0 sc0
    s_mov_b64 exec, -1
    s_lshr_b32 s7, s64, 9
    s_lshl_b32 s7, s7, 26
    s_add_u32 s68, s64, s62
    s_bfe_u32 s69, s68, 0x40000
    s_lshl_b32 s69, s69, 12
    s_or_b32 s56, s7, s69
    s_bfe_u32 s69, s68, 0x20004
    s_lshl_b32 s69, s69, 10
    s_or_b32 s56, s56, s69
    s_bfe_u32 s69, s68, 0x30006
    s_lshl_b32 s69, s69, 18
    s_or_b32 s56, s56, s69
    s_add_u32 s68, s56, 65536
    s_add_u32 s69, s56, 131072
    s_add_u32 s70, s56, 196608
    buffer_load_dwordx4 v[56:59], v1, s[44:47], s56 offen offset:0 nt
    buffer_load_dwordx4 v[60:63], v1, s[44:47], s68 offen offset:0 nt
    buffer_load_dwordx4 v[64:67], v1, s[44:47], s69 offen offset:0 nt
    buffer_load_dwordx4 v[68:71], v1, s[44:47], s70 offen offset:0 nt
    v_mov_b32_dpp v28, v24 quad_perm:[0,0,0,0] row_mask:0xf bank_mask:0xf
    v_mov_b32_dpp v29, v26 quad_perm:[2,2,2,2] row_mask:0xf bank_mask:0xf
    s_nop 0
    v_add_f32_dpp v28, v25, v28 quad_perm:[1,1,1,1] row_mask:0xf bank_mask:0xf
    v_add_f32_dpp v29, v27, v29 quad_perm:[3,3,3,3] row_mask:0xf bank_mask:0xf
    v_add_f32 v28, v28, v29
    v_cvt_pk_bf16_f32 v28, v28, v28
    v_and_b32 v28, 0xffff0000, v28
    v_mul_f32 v28, s52, v28
    v_cvt_pk_bf16_f32 v28, v28, v28
    v_and_b32 v28, 0xffff0000, v28
    v_mul_f32 v28, s53, v28
    v_cmp_lt_f32 vcc, s54, v28
    s_cbranch_vccnz Lrare_33
Lback_34:
    v_subrev_f32 v29, s54, v28
    v_exp_f32 v29, v29
    s_nop 0
    v_cvt_pk_bf16_f32 v30, v29, v29
    v_add_f32 v31, v31, v29
    s_nop 0
    v_and_b32_dpp v36, v30, v4 row_newbcast:0 row_mask:0xf bank_mask:0xf
    v_and_b32_dpp v37, v30, v5 row_newbcast:0 row_mask:0xf bank_mask:0xf
    v_and_b32_dpp v38, v30, v6 row_newbcast:0 row_mask:0xf bank_mask:0xf
    v_and_b32_dpp v39, v30, v7 row_newbcast:0 row_mask:0xf bank_mask:0xf
    v_and_b32_dpp v40, v30, v4 row_newbcast:4 row_mask:0xf bank_mask:0xf
    v_and_b32_dpp v41, v30, v5 row_newbcast:4 row_mask:0xf bank_mask:0xf
    v_and_b32_dpp v42, v30, v6 row_newbcast:4 row_mask:0xf bank_mask:0xf
    v_and_b32_dpp v43, v30, v7 row_newbcast:4 row_mask:0xf bank_mask:0xf
    v_and_b32_dpp v44, v30, v4 row_newbcast:8 row_mask:0xf bank_mask:0xf
    v_and_b32_dpp v45, v30, v5 row_newbcast:8 row_mask:0xf bank_mask:0xf
    v_and_b32_dpp v46, v30, v6 row_newbcast:8 row_mask:0xf bank_mask:0xf
    v_and_b32_dpp v47, v30, v7 row_newbcast:8 row_mask:0xf bank_mask:0xf
    v_and_b32_dpp v48, v30, v4 row_newbcast:12 row_mask:0xf bank_mask:0xf
    v_and_b32_dpp v49, v30, v5 row_newbcast:12 row_mask:0xf bank_mask:0xf
    v_and_b32_dpp v50, v30, v6 row_newbcast:12 row_mask:0xf bank_mask:0xf
    v_and_b32_dpp v51, v30, v7 row_newbcast:12 row_mask:0xf bank_mask:0xf
    s_waitcnt vmcnt(13)
    s_nop 0
    v_mfma_f32_16x16x32_bf16 v[32:35], v[36:39], v[72:75], v[32:35]
    v_mfma_f32_16x16x32_bf16 v[32:35], v[40:43], v[76:79], v[32:35]
    v_mfma_f32_16x16x32_bf16 v[32:35], v[44:47], v[80:83], v[32:35]
    v_mfma_f32_16x16x32_bf16 v[32:35], v[48:51], v[84:87], v[32:35]
    buffer_load_dwordx4 v[72:75], v2, s[48:51], s56 offen offset:0 nt
    buffer_load_dwordx4 v[76:79], v2, s[48:51], s68 offen offset:0 nt
    buffer_load_dwordx4 v[80:83], v2, s[48:51], s69 offen offset:0 nt
    buffer_load_dwordx4 v[84:87], v2, s[48:51], s70 offen offset:0 nt
    s_lshr_b32 s7, s65, 9
    s_cmp_lg_u32 s7, s57
    s_cbranch_scc1 L_sw_1
L_back_1:
    s_waitcnt vmcnt(13)
    s_add_u32 s65, s64, 4
    v_mfma_f32_16x16x32_bf16 v[24:27], v[88:91], v[8:11], 0
    v_mfma_f32_16x16x32_bf16 v[24:27], v[92:95], v[12:15], v[24:27]
    v_mfma_f32_16x16x32_bf16 v[24:27], v[96:99], v[16:19], v[24:27]
    v_mfma_f32_16x16x32_bf16 v[24:27], v[100:103], v[20:23], v[24:27]
    s_lshr_b32 s7, s65, 9
    s_lshl_b32 s7, s7, 26
    s_add_u32 s68, s65, s62
    s_bfe_u32 s69, s68, 0x40000
    s_lshl_b32 s69, s69, 12
    s_or_b32 s56, s7, s69
    s_bfe_u32 s69, s68, 0x20004
    s_lshl_b32 s69, s69, 10
    s_or_b32 s56, s56, s69
    s_bfe_u32 s69, s68, 0x30006
    s_lshl_b32 s69, s69, 18
    s_or_b32 s56, s56, s69
    s_add_u32 s68, s56, 65536
    s_add_u32 s69, s56, 131072
    s_add_u32 s70, s56, 196608
    buffer_load_dwordx4 v[88:91], v1, s[44:47], s56 offen offset:0 nt
    buffer_load_dwordx4 v[92:95], v1, s[44:47], s68 offen offset:0 nt
    buffer_load_dwordx4 v[96:99], v1, s[44:47], s69 offen offset:0 nt
    buffer_load_dwordx4 v[100:103], v1, s[44:47], s70 offen offset:0 nt
    v_mov_b32_dpp v28, v24 quad_perm:[0,0,0,0] row_mask:0xf bank_mask:0xf
    v_mov_b32_dpp v29, v26 quad_perm:[2,2,2,2] row_mask:0xf bank_mask:0xf
    s_nop 0
    v_add_f32_dpp v28, v25, v28 quad_perm:[1,1,1,1] row_mask:0xf bank_mask:0xf
    v_add_f32_dpp v29, v27, v29 quad_perm:[3,3,3,3] row_mask:0xf bank_mask:0xf
    v_add_f32 v28, v28, v29
    v_cvt_pk_bf16_f32 v28, v28, v28
    v_and_b32 v28, 0xffff0000, v28
    v_mul_f32 v28, s52, v28
    v_cvt_pk_bf16_f32 v28, v28, v28
    v_and_b32 v28, 0xffff0000, v28
    v_mul_f32 v28, s53, v28
    v_cmp_lt_f32 vcc, s54, v28
    s_cbranch_vccnz Lrare_35
Lback_36:
    v_subrev_f32 v29, s54, v28
    v_exp_f32 v29, v29
    s_nop 0
    v_cvt_pk_bf16_f32 v30, v29, v29
    v_add_f32 v31, v31, v29
    s_nop 0
    v_and_b32_dpp v36, v30, v4 row_newbcast:0 row_mask:0xf bank_mask:0xf
    v_and_b32_dpp v37, v30, v5 row_newbcast:0 row_mask:0xf bank_mask:0xf
    v_and_b32_dpp v38, v30, v6 row_newbcast:0 row_mask:0xf bank_mask:0xf
    v_and_b32_dpp v39, v30, v7 row_newbcast:0 row_mask:0xf bank_mask:0xf
    v_and_b32_dpp v40, v30, v4 row_newbcast:4 row_mask:0xf bank_mask:0xf
    v_and_b32_dpp v41, v30, v5 row_newbcast:4 row_mask:0xf bank_mask:0xf
    v_and_b32_dpp v42, v30, v6 row_newbcast:4 row_mask:0xf bank_mask:0xf
    v_and_b32_dpp v43, v30, v7 row_newbcast:4 row_mask:0xf bank_mask:0xf
    v_and_b32_dpp v44, v30, v4 row_newbcast:8 row_mask:0xf bank_mask:0xf
    v_and_b32_dpp v45, v30, v5 row_newbcast:8 row_mask:0xf bank_mask:0xf
    v_and_b32_dpp v46, v30, v6 row_newbcast:8 row_mask:0xf bank_mask:0xf
    v_and_b32_dpp v47, v30, v7 row_newbcast:8 row_mask:0xf bank_mask:0xf
    v_and_b32_dpp v48, v30, v4 row_newbcast:12 row_mask:0xf bank_mask:0xf
    v_and_b32_dpp v49, v30, v5 row_newbcast:12 row_mask:0xf bank_mask:0xf
    v_and_b32_dpp v50, v30, v6 row_newbcast:12 row_mask:0xf bank_mask:0xf
    v_and_b32_dpp v51, v30, v7 row_newbcast:12 row_mask:0xf bank_mask:0xf
    s_waitcnt vmcnt(13)
    s_nop 0
    v_mfma_f32_16x16x32_bf16 v[32:35], v[36:39], v[104:107], v[32:35]
    v_mfma_f32_16x16x32_bf16 v[32:35], v[40:43], v[108:111], v[32:35]
    v_mfma_f32_16x16x32_bf16 v[32:35], v[44:47], v[112:115], v[32:35]
    v_mfma_f32_16x16x32_bf16 v[32:35], v[48:51], v[116:119], v[32:35]
    buffer_load_dwordx4 v[104:107], v2, s[48:51], s56 offen offset:0 nt
    buffer_load_dwordx4 v[108:111], v2, s[48:51], s68 offen offset:0 nt
    buffer_load_dwordx4 v[112:115], v2, s[48:51], s69 offen offset:0 nt
    buffer_load_dwordx4 v[116:119], v2, s[48:51], s70 offen offset:0 nt
    s_branch L_loop
L_sw_0:
    s_mov_b32 s58, 0
    s_branch L_switch
L_sw_1:
    s_mov_b32 s58, 1
    s_branch L_switch
L_switch:
L_flush:
    v_add_f32_dpp v52, v31, v31 row_ror:4 row_mask:0xf bank_mask:0xf
    v_and_b32 v28, 15, v0
    v_lshlrev_b32 v28, 5, v28
    v_add_f32_dpp v52, v52, v52 row_ror:8 row_mask:0xf bank_mask:0xf
    v_bfe_u32 v29, v0, 4, 1
    v_lshl_add_u32 v28, v29, 4, v28
    v_add_f32_dpp v52, v52, v52 row_bcast:15 row_mask:0xa bank_mask:0xf
    v_add_u32 v28, s60, v28
    v_mov_b32 v40, s54
    v_add_f32_dpp v41, v52, v52 row_bcast:31 row_mask:0xc bank_mask:0xf
    v_mov_b32 v29, s61
    v_mov_b32 v30, 18444
    v_mov_b32 v53, 1
    s_mov_b32 exec_hi, 0
    ds_write_b128 v28, v[32:35]
    s_mov_b32 exec_lo, 0
    s_mov_b32 exec_hi, 0x80000000
    ds_write_b64 v29, v[40:41]
    ds_add_u32 v30, v53
    s_mov_b64 exec, -1
    s_add_u32 s57, s57, 1
    s_add_u32 s60, s60, 2048
    s_add_u32 s61, s61, 32
    s_cmp_ge_u32 s57, 4
    s_cbranch_scc1 L_sdone
L_newq:
    v_mov_b32 v31, 0
    v_mov_b32 v32, 0
    v_mov_b32 v33, 0
    v_mov_b32 v34, 0
    v_mov_b32 v35, 0
    s_mov_b32 s54, 0xff800000
    s_cmp_lt_u32 s58, 2
    s_cselect_b32 s8, s7, 0
    s_cmp_lt_u32 s57, s8
    s_cbranch_scc1 L_flush
    v_lshrrev_b32 v28, 4, v0
    v_and_b32 v29, 3, v0
    v_lshl_add_u32 v28, v28, 2, v29
    v_lshlrev_b32 v28, 4, v28
    s_lshl_b32 s8, s57, 8
    v_add_u32 v28, s8, v28
    ds_read_b128 v[24:27], v28 offset:16384
    v_bfe_u32 v53, v0, 2, 2
    s_waitcnt lgkmcnt(0)
    v_cmp_eq_u32 vcc, 0, v53
    s_nop 1
    v_cndmask_b32 v8, 0, v24, vcc
    v_cndmask_b32 v9, 0, v25, vcc
    v_cndmask_b32 v10, 0, v26, vcc
    v_cndmask_b32 v11, 0, v27, vcc
    v_cmp_eq_u32 vcc, 1, v53
    s_nop 1
    v_cndmask_b32 v12, 0, v24, vcc
    v_cndmask_b32 v13, 0, v25, vcc
    v_cndmask_b32 v14, 0, v26, vcc
    v_cndmask_b32 v15, 0, v27, vcc
    v_cmp_eq_u32 vcc, 2, v53
    s_nop 1
    v_cndmask_b32 v16, 0, v24, vcc
    v_cndmask_b32 v17, 0, v25, vcc
    v_cndmask_b32 v18, 0, v26, vcc
    v_cndmask_b32 v19, 0, v27, vcc
    v_cmp_eq_u32 vcc, 3, v53
    s_nop 1
    v_cndmask_b32 v20, 0, v24, vcc
    v_cndmask_b32 v21, 0, v25, vcc
    v_cndmask_b32 v22, 0, v26, vcc
    v_cndmask_b32 v23, 0, v27, vcc
    s_cmp_eq_u32 s58, 0
    s_cbranch_scc1 L_back_0
    s_cmp_eq_u32 s58, 1
    s_cbranch_scc1 L_back_1
    s_branch L_back_2
L_sdone:
    s_waitcnt lgkmcnt(0)
    s_endpgm
L_end:
    s_endpgm
Lrare_23:
    s_nop 0
    v_max_f32_dpp v52, v28, v28 row_ror:4 row_mask:0xf bank_mask:0xf
    s_nop 1
    v_max_f32_dpp v52, v52, v52 row_ror:8 row_mask:0xf bank_mask:0xf
    s_nop 1
    v_max_f32_dpp v52, v52, v52 row_bcast:15 row_mask:0xa bank_mask:0xf
    s_nop 1
    v_max_f32_dpp v52, v52, v52 row_bcast:31 row_mask:0xc bank_mask:0xf
    v_mov_b32 v53, s54
    s_nop 0
    v_readlane_b32 s55, v52, 63
    s_nop 3
    v_subrev_f32 v53, s55, v53
    v_exp_f32 v53, v53
    s_mov_b32 s54, s55
    s_nop 0
    v_mul_f32 v32, v32, v53
    v_mul_f32 v33, v33, v53
    v_mul_f32 v34, v34, v53
    v_mul_f32 v35, v35, v53
    v_mul_f32 v31, v31, v53
    s_branch Lback_24
Lrare_25:
    s_nop 0
    v_max_f32_dpp v52, v28, v28 row_ror:4 row_mask:0xf bank_mask:0xf
    s_nop 1
    v_max_f32_dpp v52, v52, v52 row_ror:8 row_mask:0xf bank_mask:0xf
    s_nop 1
    v_max_f32_dpp v52, v52, v52 row_bcast:15 row_mask:0xa bank_mask:0xf
    s_nop 1
    v_max_f32_dpp v52, v52, v52 row_bcast:31 row_mask:0xc bank_mask:0xf
    v_mov_b32 v53, s54
    s_nop 0
    v_readlane_b32 s55, v52, 63
    s_nop 3
    v_subrev_f32 v53, s55, v53
    v_exp_f32 v53, v53
    s_mov_b32 s54, s55
    s_nop 0
    v_mul_f32 v32, v32, v53
    v_mul_f32 v33, v33, v53
    v_mul_f32 v34, v34, v53
    v_mul_f32 v35, v35, v53
    v_mul_f32 v31, v31, v53
    s_branch Lback_26
Lrare_27:
    s_nop 0
    v_max_f32_dpp v52, v28, v28 row_ror:4 row_mask:0xf bank_mask:0xf
    s_nop 1
    v_max_f32_dpp v52, v52, v52 row_ror:8 row_mask:0xf bank_mask:0xf
    s_nop 1
    v_max_f32_dpp v52, v52, v52 row_bcast:15 row_mask:0xa bank_mask:0xf
    s_nop 1
    v_max_f32_dpp v52, v52, v52 row_bcast:31 row_mask:0xc bank_mask:0xf
    v_mov_b32 v53, s54
    s_nop 0
    v_readlane_b32 s55, v52, 63
    s_nop 3
    v_subrev_f32 v53, s55, v53
    v_exp_f32 v53, v53
    s_mov_b32 s54, s55
    s_nop 0
    v_mul_f32 v32, v32, v53
    v_mul_f32 v33, v33, v53
    v_mul_f32 v34, v34, v53
    v_mul_f32 v35, v35, v53
    v_mul_f32 v31, v31, v53
    s_branch Lback_28
Lrare_29:
    s_nop 0
    v_max_f32_dpp v52, v28, v28 row_ror:4 row_mask:0xf bank_mask:0xf
    s_nop 1
    v_max_f32_dpp v52, v52, v52 row_ror:8 row_mask:0xf bank_mask:0xf
    s_nop 1
    v_max_f32_dpp v52, v52, v52 row_bcast:15 row_mask:0xa bank_mask:0xf
    s_nop 1
    v_max_f32_dpp v52, v52, v52 row_bcast:31 row_mask:0xc bank_mask:0xf
    v_mov_b32 v53, s54
    s_nop 0
    v_readlane_b32 s55, v52, 63
    s_nop 3
    v_subrev_f32 v53, s55, v53
    v_exp_f32 v53, v53
    s_mov_b32 s54, s55
    s_nop 0
    v_mul_f32 v32, v32, v53
    v_mul_f32 v33, v33, v53
    v_mul_f32 v34, v34, v53
    v_mul_f32 v35, v35, v53
    v_mul_f32 v31, v31, v53
    s_branch Lback_30
Lrare_31:
    s_nop 0
    v_max_f32_dpp v52, v28, v28 row_ror:4 row_mask:0xf bank_mask:0xf
    s_nop 1
    v_max_f32_dpp v52, v52, v52 row_ror:8 row_mask:0xf bank_mask:0xf
    s_nop 1
    v_max_f32_dpp v52, v52, v52 row_bcast:15 row_mask:0xa bank_mask:0xf
    s_nop 1
    v_max_f32_dpp v52, v52, v52 row_bcast:31 row_mask:0xc bank_mask:0xf
    v_mov_b32 v53, s54
    s_nop 0
    v_readlane_b32 s55, v52, 63
    s_nop 3
    v_subrev_f32 v53, s55, v53
    v_exp_f32 v53, v53
    s_mov_b32 s54, s55
    s_nop 0
    v_mul_f32 v32, v32, v53
    v_mul_f32 v33, v33, v53
    v_mul_f32 v34, v34, v53
    v_mul_f32 v35, v35, v53
    v_mul_f32 v31, v31, v53
    s_branch Lback_32
Lrare_33:
    s_nop 0
    v_max_f32_dpp v52, v28, v28 row_ror:4 row_mask:0xf bank_mask:0xf
    s_nop 1
    v_max_f32_dpp v52, v52, v52 row_ror:8 row_mask:0xf bank_mask:0xf
    s_nop 1
    v_max_f32_dpp v52, v52, v52 row_bcast:15 row_mask:0xa bank_mask:0xf
    s_nop 1
    v_max_f32_dpp v52, v52, v52 row_bcast:31 row_mask:0xc bank_mask:0xf
    v_mov_b32 v53, s54
    s_nop 0
    v_readlane_b32 s55, v52, 63
    s_nop 3
    v_subrev_f32 v53, s55, v53
    v_exp_f32 v53, v53
    s_mov_b32 s54, s55
    s_nop 0
    v_mul_f32 v32, v32, v53
    v_mul_f32 v33, v33, v53
    v_mul_f32 v34, v34, v53
    v_mul_f32 v35, v35, v53
    v_mul_f32 v31, v31, v53
    s_branch Lback_34
Lrare_35:
    s_nop 0
    v_max_f32_dpp v52, v28, v28 row_ror:4 row_mask:0xf bank_mask:0xf
    s_nop 1
    v_max_f32_dpp v52, v52, v52 row_ror:8 row_mask:0xf bank_mask:0xf
    s_nop 1
    v_max_f32_dpp v52, v52, v52 row_bcast:15 row_mask:0xa bank_mask:0xf
    s_nop 1
    v_max_f32_dpp v52, v52, v52 row_bcast:31 row_mask:0xc bank_mask:0xf
    v_mov_b32 v53, s54
    s_nop 0
    v_readlane_b32 s55, v52, 63
    s_nop 3
    v_subrev_f32 v53, s55, v53
    v_exp_f32 v53, v53
    s_mov_b32 s54, s55
    s_nop 0
    v_mul_f32 v32, v32, v53
    v_mul_f32 v33, v33, v53
    v_mul_f32 v34, v34, v53
    v_mul_f32 v35, v35, v53
    v_mul_f32 v31, v31, v53
    s_branch Lback_36
.section .rodata,"a"
.p2align 6
.amdhsa_kernel gated_mix__mha_block_cached__moe_arch_mod__decode_kernel
  .amdhsa_next_free_vgpr 256
  .amdhsa_next_free_sgpr 96
  .amdhsa_accum_offset 256
  .amdhsa_group_segment_fixed_size 0
  .amdhsa_kernarg_size 112
  .amdhsa_user_sgpr_count 2
  .amdhsa_user_sgpr_kernarg_segment_ptr 1
  .amdhsa_system_sgpr_workgroup_id_x 1
.end_amdhsa_kernel
```
